```python
import torch

def _softmax(x, axis=-1):
    return torch.softmax(x, dim=axis)
def _gelu(x):
    return torch.nn.functional.gelu(x, approximate="tanh")
def _silu(x):
    return torch.nn.functional.silu(x)
def _sigmoid(x):
    return torch.sigmoid(x)
def _layernorm(x, axis=-1, eps=1e-5):
    m = x.mean(dim=axis, keepdim=True)
    v = x.var(dim=axis, keepdim=True, unbiased=False)
    return (x - m) / torch.sqrt(v + eps)
def _scatter_add(tgt, idx, src, axis=0):
    return tgt.clone().index_add_(axis, idx, src)
def _segment_sum(src, seg, n):
    out = torch.zeros((n,) + src.shape[1:], dtype=src.dtype)
    return out.index_add_(0, seg, src)
def _pad(x, pw):
    flat = tuple(v for pair in reversed(pw) for v in pair)
    return torch.nn.functional.pad(x, flat)

kernel_name = 'standalone__paged_block_table_kv_pagedattention__prompt'

def setup_inputs():

    _w = (lambda a: (lambda t: t.to(torch.bfloat16) if t.is_floating_point() else t)(torch.as_tensor(a)))
    B, Hq, Hkv, Sq, Skv, D = 1, 32, 16, 2048, 2048, 128
    bs = 16
    nbps = max(1, Skv // bs)
    num_phys = B * nbps + 4
    bt = torch.randperm(num_phys)[: B * nbps].reshape(B, nbps).to(torch.int64)
    cl = (nbps * bs - (torch.arange(1, B + 1, dtype=torch.int64) * 2654435761) % max(1, nbps * bs // 2)).to(torch.int64)
    return {
        "q": _w((lambda *s: torch.randn(*s, dtype=torch.bfloat16) * 0.8)(B, Hq, Sq, D)),
        "k_cache": _w((lambda *s: torch.randn(*s, dtype=torch.bfloat16) * 0.8)(num_phys, bs, Hkv, D)),
        "v_cache": _w((lambda *s: torch.randn(*s, dtype=torch.bfloat16) * 0.05)(num_phys, bs, Hkv, D)),
        "block_table": _w(bt),
        "context_lens": _w(cl),
    }

def reference(q, k_cache, v_cache, block_table, context_lens):
    B, Hq, Sq, D = q.shape
    bs = k_cache.shape[1]
    Hkv = k_cache.shape[2]
    nbps = block_table.shape[1]
    Skv = nbps * bs
    bt = block_table.reshape(-1)
    k = (lambda x, *d: x.permute(*d))(k_cache[bt].reshape(B, Skv, Hkv, D), 0, 2, 1, 3)
    v = (lambda x, *d: x.permute(*d))(v_cache[bt].reshape(B, Skv, Hkv, D), 0, 2, 1, 3)
    g = Hq // Hkv
    qg = q.reshape(B, Hkv, g, Sq, D)
    scores = torch.einsum("bhgqd,bhkd->bhgqk", qg, k) * (D ** -0.5)
    pos = torch.arange(Skv)
    msk = pos[None, :] < context_lens[:, None]
    scores = torch.where(msk[:, None, None, None, :], scores, -1e9)
    p = _softmax(scores, axis=-1)
    out = torch.einsum("bhgqk,bhkd->bhgqd", p, v)
    return out.reshape(B, Hq, Sq, D)
```

```asm
; @launch grid=(256,1,1) block=(256,1,1) lds=163840
.amdgcn_target "amdgcn-amd-amdhsa--gfx950"
.text
.globl standalone__paged_block_table_kv_pagedattention__prompt_kernel
.p2align 8
.type standalone__paged_block_table_kv_pagedattention__prompt_kernel,@function
standalone__paged_block_table_kv_pagedattention__prompt_kernel:
    s_cmp_ge_u32 s2, 256
    s_cbranch_scc1 L_end
    s_load_dwordx16 s[16:31], s[0:1], 0
    s_getpc_b64 s[66:67]
L_pc:
    s_cmp_lt_u32 s2, 64
    s_cselect_b32 s68, L_code_end-L_pc-4, 0
    v_lshlrev_b32 v14, 7, v0
    v_min_u32 v14, s68, v14
    v_mov_b32 v13, s67
    v_add_co_u32 v12, vcc, s66, v14
    s_nop 1
    v_addc_co_u32 v13, vcc, 0, v13, vcc
    global_load_dword v15, v[12:13], off
    v_lshrrev_b32 v1, 6, v0
    v_and_b32 v2, 63, v0
    v_readfirstlane_b32 s3, v1
    s_and_b32 s7, s2, 7
    s_lshl_b32 s7, s7, 1
    s_bfe_u32 s15, s2, 0x10003
    s_add_u32 s15, s15, s7
    s_lshr_b32 s7, s2, 4
    s_lshl4_add_u32 s14, s15, s7
    s_lshl2_add_u32 s14, s14, s3
    s_lshl_b32 s14, s14, 14
    s_lshl_b32 s12, s3, 12
    v_lshrrev_b32 v3, 4, v2
    v_and_b32 v4, 15, v2
    v_xor_b32 v11, v4, v3
    v_lshlrev_b32 v11, 4, v11
    v_lshl_add_u32 v5, v3, 8, v11
    v_and_b32 v9, 31, v2
    s_lshl_b32 s34, s3, 2
    v_lshl_add_u32 v9, v9, 4, s34
    s_mov_b32 s54, 512
    s_mov_b32 s55, 0x20000
    s_mov_b32 s38, 16777216
    s_mov_b32 s39, 0x20000
    v_xor_b32 v6, 64, v5
    v_xor_b32 v7, 128, v5
    v_xor_b32 v8, 192, v5
    s_add_u32 m0, s12, 16384
    s_waitcnt lgkmcnt(0)
    s_mov_b32 s52, s22
    s_and_b32 s53, s23, 0xffff
    buffer_load_dword v100, v9, s[52:55], 0 offen
    s_load_dword s4, s[24:25], 0
    s_mov_b32 s36, s16
    s_and_b32 s37, s17, 0xffff
    s_cmp_ge_u32 s2, 128
    s_cbranch_scc1 L_noq
    buffer_load_dwordx4 v5, s[36:39], s14 offen lds
    buffer_load_dwordx4 v6, s[36:39], s14 offen offset:1024 lds
    buffer_load_dwordx4 v7, s[36:39], s14 offen offset:2048 lds
    buffer_load_dwordx4 v8, s[36:39], s14 offen offset:3072 lds
    s_add_u32 m0, s12, 81920
    s_add_u32 s45, s14, 4096
    buffer_load_dwordx4 v5, s[36:39], s45 offen lds
    buffer_load_dwordx4 v6, s[36:39], s45 offen offset:1024 lds
    buffer_load_dwordx4 v7, s[36:39], s45 offen offset:2048 lds
    buffer_load_dwordx4 v8, s[36:39], s45 offen offset:3072 lds
L_noq:
    s_lshl_b32 s15, s15, 8
    s_add_u32 s13, s12, 65536
    v_lshl_add_u32 v92, v3, 12, v11
    v_lshlrev_b32_e64 v1, 1, v3
    v_xor_b32_e64 v1, v4, v1
    v_lshlrev_b32_e64 v1, 4, v1
    v_lshl_add_u32 v96, v3, 12, v1
    v_xor_b32_e64 v1, 64, v92
    v_add_u32 v93, 15360, v1
    v_xor_b32 v1, 0x80, v96
    v_add_u32 v97, 15360, v1
    v_xor_b32 v1, 128, v92
    v_add_u32 v94, 30720, v1
    v_add_u32 v98, 30720, v96
    v_xor_b32 v1, 192, v92
    v_add_u32 v95, 46080, v1
    v_xor_b32 v1, 0x80, v96
    v_add_u32 v99, 46080, v1
    s_mov_b32 s50, 16777216
    s_mov_b32 s51, 0x20000
    s_mov_b32 s48, s26
    s_and_b32 s49, s27, 0xffff
    v_lshl_add_u32 v80, v4, 8, v11
    v_lshlrev_b32_e64 v103, 2, v3
    v_xor_b32_e64 v81, 64, v80
    v_xor_b32 v82, 128, v80
    v_xor_b32 v83, 192, v80
    v_add_u32_e64 v120, s12, v80
    v_add_u32_e64 v124, s13, v80
    v_add_u32_e64 v121, s12, v81
    v_add_u32_e64 v125, s13, v81
    v_add_u32 v122, s12, v82
    v_add_u32 v126, s13, v82
    v_add_u32 v123, s12, v83
    v_add_u32 v127, s13, v83
    v_lshrrev_b32 v1, 2, v2
    v_and_b32 v11, 7, v1
    v_lshlrev_b32 v11, 5, v11
    v_lshl_add_u32 v11, v1, 8, v11
    v_and_b32 v1, 3, v4
    v_lshl_add_u32 v11, v1, 3, v11
    v_add_u32 v84, 65536, v11
    v_xor_b32 v85, 32, v84
    v_xor_b32 v86, 64, v84
    v_xor_b32 v87, 96, v84
    v_xor_b32 v88, 128, v84
    v_xor_b32 v89, 160, v84
    v_xor_b32 v90, 192, v84
    v_xor_b32 v91, 224, v84
    v_mov_b32 v102, 0xff800000
    v_mov_b32 v1, 0x3f803f80
    v_accvgpr_write_b32 a212, 0
    v_accvgpr_write_b32 a208, v1
    v_accvgpr_write_b32 a213, 0
    v_accvgpr_write_b32 a209, v1
    v_accvgpr_write_b32 a214, 0
    v_accvgpr_write_b32 a210, v1
    v_accvgpr_write_b32 a215, 0
    v_accvgpr_write_b32 a211, v1
    v_and_b32 v1, 1, v2
    v_mul_u32_u24 v1, 0xaaaa, v1
    v_add_u32 v1, 0x4444, v1
    v_lshl_or_b32 v101, v1, 16, v1
    v_bfe_u32 v1, v2, 1, 1
    v_mul_u32_u24 v1, 0xaaaa, v1
    v_add_u32 v1, 0x4444, v1
    v_lshl_or_b32 v0, v1, 16, v1
    v_accvgpr_write_b32 a217, 0
    v_accvgpr_write_b32 a219, 0
    v_accvgpr_write_b32 a220, 0
    v_accvgpr_write_b32 a222, 0
    v_accvgpr_write_b32 a225, 0
    v_accvgpr_write_b32 a226, 0
    v_accvgpr_write_b32 a227, 0
    s_nop 0
    v_mfma_f32_32x32x16_bf16 a[192:207], a[212:215], a[212:215], 0
    v_mfma_f32_32x32x16_bf16 v[48:63], a[212:215], a[212:215], 0
    s_waitcnt lgkmcnt(0)
    s_cmp_le_i32 s4, 0
    s_cselect_b32 s35, 1, 0
    s_cselect_b32 s32, 0, 0xb9d83e03
    s_cselect_b32 s4, 0x800, s4
    s_min_u32 s4, s4, 0x800
    s_add_u32 s5, s4, 63
    s_lshr_b32 s5, s5, 6
    s_sub_u32 s8, s5, 1
    s_lshl_b32 s34, s8, 6
    s_cmp_lt_u32 s2, 128
    s_cbranch_scc1 L_btw
    s_waitcnt vmcnt(0)
L_btw:
    s_waitcnt vmcnt(8)
    v_min_u32 v100, 0x83, v100
    v_lshlrev_b32 v100, 16, v100
    v_add_u32 v100, s15, v100
    s_nop 0
    v_readlane_b32 s7, v100, s8
    s_nop 1
    s_add_u32 s40, s18, s7
    s_addc_u32 s41, s19, 0
    s_add_u32 m0, s12, 49152
    s_nop 0
    global_load_lds_dwordx4 v92, s[40:41]
    global_load_lds_dwordx4 v93, s[40:41] offset:1024
    s_sub_u32 s6, s4, s34
    global_load_lds_dwordx4 v94, s[40:41] offset:2048
    s_add_u32 s9, s5, 1
    global_load_lds_dwordx4 v95, s[40:41] offset:3072
    v_readlane_b32 s11, v100, 0
    s_add_u32 s42, s20, s7
    s_addc_u32 s43, s21, 0
    s_add_u32 m0, s13, 49152
    s_nop 0
    global_load_lds_dwordx4 v96, s[42:43]
    v_readlane_b32 s44, v100, 1
    global_load_lds_dwordx4 v97, s[42:43] offset:1024
    v_readlane_b32 s10, v100, 2
    global_load_lds_dwordx4 v98, s[42:43] offset:2048
    s_mov_b32 s8, 3
    global_load_lds_dwordx4 v99, s[42:43] offset:3072
    v_sub_u32 v10, s6, v103
    s_cmp_ge_u32 s2, 128
    s_cbranch_scc1 L_var1
    v_cmp_lt_i32 s[60:61], 0, v10
    v_cmp_lt_i32 s[62:63], 1, v10
    v_mfma_f32_32x32x16_bf16 v[128:143], a[212:215], a[212:215], 0
    v_cmp_lt_i32 s[64:65], 2, v10
    v_cmp_lt_i32 s[66:67], 3, v10
    v_cmp_lt_i32 s[68:69], 16, v10
    v_mfma_f32_32x32x16_bf16 v[144:159], a[212:215], a[212:215], 0
    v_cmp_lt_i32 s[70:71], 17, v10
    v_cmp_lt_i32 s[72:73], 18, v10
    v_cmp_lt_i32 s[74:75], 19, v10
    v_mfma_f32_32x32x16_bf16 v[160:175], a[212:215], a[212:215], 0
    v_cmp_lt_i32 s[76:77], 32, v10
    v_cmp_lt_i32 s[78:79], 33, v10
    v_cmp_lt_i32 s[80:81], 34, v10
    v_mfma_f32_32x32x16_bf16 v[176:191], a[212:215], a[212:215], 0
    v_cmp_lt_i32 s[82:83], 35, v10
    v_cmp_lt_i32 s[84:85], 48, v10
    v_cmp_lt_i32 s[86:87], 49, v10
    v_mfma_f32_32x32x16_bf16 v[192:207], a[212:215], a[212:215], 0
    v_cmp_lt_i32 s[88:89], 50, v10
    v_cmp_lt_i32 s[90:91], 51, v10
    v_lshrrev_b32 v1, 5, v2
    v_mfma_f32_32x32x16_bf16 v[208:223], a[212:215], a[212:215], 0
    v_lshlrev_b32 v1, 4, v1
    v_lshrrev_b32 v1, v1, s32
    v_and_b32 v1, 0xffff, v1
    v_mfma_f32_32x32x16_bf16 v[224:239], a[212:215], a[212:215], 0
    v_and_b32 v11, 1, v4
    v_lshlrev_b32 v11, 4, v11
    v_lshlrev_b32 v1, v11, v1
    v_mfma_f32_32x32x16_bf16 v[240:255], a[212:215], a[212:215], 0
    v_and_b32 v11, 1, v3
    v_lshlrev_b32 v11, 1, v11
    v_lshrrev_b32 v12, 2, v4
    v_cmp_eq_u32 vcc, v11, v12
    v_add_u32 v11, 1, v11
    v_cmp_eq_u32 s[24:25], v11, v12
    v_cndmask_b32 v11, 0, v1, vcc
    s_nop 0
    v_cndmask_b32 v1, 0, v1, s[24:25]
    v_accvgpr_write_b32 a216, v11
    v_accvgpr_write_b32 a221, v11
    v_accvgpr_write_b32 a218, v1
    v_accvgpr_write_b32 a223, v1
    s_waitcnt vmcnt(12)
    ds_read_b128 v[16:19], v120 offset:16384
    ds_read_b128 v[20:23], v120 offset:16384
    ds_read_b128 v[24:27], v121 offset:16384
    ds_read_b128 v[28:31], v121 offset:16384
    ds_read_b128 v[32:35], v122 offset:16384
    ds_read_b128 v[36:39], v122 offset:16384
    ds_read_b128 v[40:43], v123 offset:16384
    ds_read_b128 v[44:47], v123 offset:16384
    s_waitcnt lgkmcnt(6)
    v_smfmac_f32_16x16x64_bf16 v[128:131], a[216:219], v[16:23], v0
    s_add_u32 m0, s12, 32768
    s_add_u32 s46, s14, 8192
    buffer_load_dwordx4 v5, s[36:39], s46 offen lds
    v_smfmac_f32_16x16x64_bf16 v[132:135], a[220:223], v[16:23], v0
    s_waitcnt lgkmcnt(4)
    v_smfmac_f32_16x16x64_bf16 v[136:139], a[216:219], v[24:31], v0
    buffer_load_dwordx4 v6, s[36:39], s46 offen offset:1024 lds
    s_nop 4
    v_cvt_pk_bf16_f32 v128, v128, v129
    v_cvt_pk_bf16_f32 v129, v130, v131
    v_accvgpr_write_b32 a128, v128
    v_accvgpr_write_b32 a129, v129
    v_smfmac_f32_16x16x64_bf16 v[140:143], a[220:223], v[24:31], v0
    v_cvt_pk_bf16_f32 v132, v132, v133
    v_cvt_pk_bf16_f32 v133, v134, v135
    v_accvgpr_write_b32 a130, v132
    v_accvgpr_write_b32 a131, v133
    s_waitcnt lgkmcnt(2)
    v_smfmac_f32_16x16x64_bf16 v[144:147], a[216:219], v[32:39], v0
    buffer_load_dwordx4 v7, s[36:39], s46 offen offset:2048 lds
    v_cvt_pk_bf16_f32 v136, v136, v137
    v_cvt_pk_bf16_f32 v137, v138, v139
    v_accvgpr_write_b32 a132, v136
    v_accvgpr_write_b32 a133, v137
    v_smfmac_f32_16x16x64_bf16 v[148:151], a[220:223], v[32:39], v0
    v_cvt_pk_bf16_f32 v140, v140, v141
    v_cvt_pk_bf16_f32 v141, v142, v143
    v_accvgpr_write_b32 a134, v140
    v_accvgpr_write_b32 a135, v141
    s_waitcnt lgkmcnt(0)
    v_smfmac_f32_16x16x64_bf16 v[152:155], a[216:219], v[40:47], v0
    buffer_load_dwordx4 v8, s[36:39], s46 offen offset:3072 lds
    v_cvt_pk_bf16_f32 v144, v144, v145
    v_cvt_pk_bf16_f32 v145, v146, v147
    v_accvgpr_write_b32 a136, v144
    v_accvgpr_write_b32 a137, v145
    v_smfmac_f32_16x16x64_bf16 v[156:159], a[220:223], v[40:47], v0
    v_cvt_pk_bf16_f32 v148, v148, v149
    v_cvt_pk_bf16_f32 v149, v150, v151
    v_accvgpr_write_b32 a138, v148
    v_accvgpr_write_b32 a139, v149
    s_nop 2
    v_cvt_pk_bf16_f32 v152, v152, v153
    v_cvt_pk_bf16_f32 v153, v154, v155
    v_accvgpr_write_b32 a140, v152
    v_accvgpr_write_b32 a141, v153
    v_cvt_pk_bf16_f32 v156, v156, v157
    v_cvt_pk_bf16_f32 v157, v158, v159
    v_accvgpr_write_b32 a142, v156
    v_accvgpr_write_b32 a143, v157
    s_waitcnt vmcnt(12)
    ds_read_b128 v[16:19], v124 offset:16384
    ds_read_b128 v[20:23], v124 offset:16384
    ds_read_b128 v[24:27], v125 offset:16384
    ds_read_b128 v[28:31], v125 offset:16384
    ds_read_b128 v[32:35], v126 offset:16384
    ds_read_b128 v[36:39], v126 offset:16384
    ds_read_b128 v[40:43], v127 offset:16384
    ds_read_b128 v[44:47], v127 offset:16384
    s_waitcnt lgkmcnt(6)
    v_smfmac_f32_16x16x64_bf16 v[160:163], a[216:219], v[16:23], v0
    s_add_u32 m0, s12, 98304
    s_add_u32 s47, s14, 12288
    buffer_load_dwordx4 v5, s[36:39], s47 offen lds
    v_smfmac_f32_16x16x64_bf16 v[164:167], a[220:223], v[16:23], v0
    s_waitcnt lgkmcnt(4)
    v_smfmac_f32_16x16x64_bf16 v[168:171], a[216:219], v[24:31], v0
    buffer_load_dwordx4 v6, s[36:39], s47 offen offset:1024 lds
    s_nop 4
    v_cvt_pk_bf16_f32 v160, v160, v161
    v_cvt_pk_bf16_f32 v161, v162, v163
    v_accvgpr_write_b32 a144, v160
    v_accvgpr_write_b32 a145, v161
    v_smfmac_f32_16x16x64_bf16 v[172:175], a[220:223], v[24:31], v0
    v_cvt_pk_bf16_f32 v164, v164, v165
    v_cvt_pk_bf16_f32 v165, v166, v167
    v_accvgpr_write_b32 a146, v164
    v_accvgpr_write_b32 a147, v165
    s_waitcnt lgkmcnt(2)
    v_smfmac_f32_16x16x64_bf16 v[176:179], a[216:219], v[32:39], v0
    buffer_load_dwordx4 v7, s[36:39], s47 offen offset:2048 lds
    v_cvt_pk_bf16_f32 v168, v168, v169
    v_cvt_pk_bf16_f32 v169, v170, v171
    v_accvgpr_write_b32 a148, v168
    v_accvgpr_write_b32 a149, v169
    v_smfmac_f32_16x16x64_bf16 v[180:183], a[220:223], v[32:39], v0
    v_cvt_pk_bf16_f32 v172, v172, v173
    v_cvt_pk_bf16_f32 v173, v174, v175
    v_accvgpr_write_b32 a150, v172
    v_accvgpr_write_b32 a151, v173
    s_waitcnt lgkmcnt(0)
    v_smfmac_f32_16x16x64_bf16 v[184:187], a[216:219], v[40:47], v0
    buffer_load_dwordx4 v8, s[36:39], s47 offen offset:3072 lds
    v_cvt_pk_bf16_f32 v176, v176, v177
    v_cvt_pk_bf16_f32 v177, v178, v179
    v_accvgpr_write_b32 a152, v176
    v_accvgpr_write_b32 a153, v177
    v_smfmac_f32_16x16x64_bf16 v[188:191], a[220:223], v[40:47], v0
    v_cvt_pk_bf16_f32 v180, v180, v181
    v_cvt_pk_bf16_f32 v181, v182, v183
    v_accvgpr_write_b32 a154, v180
    v_accvgpr_write_b32 a155, v181
    s_nop 2
    v_cvt_pk_bf16_f32 v184, v184, v185
    v_cvt_pk_bf16_f32 v185, v186, v187
    v_accvgpr_write_b32 a156, v184
    v_accvgpr_write_b32 a157, v185
    v_cvt_pk_bf16_f32 v188, v188, v189
    v_cvt_pk_bf16_f32 v189, v190, v191
    v_accvgpr_write_b32 a158, v188
    v_accvgpr_write_b32 a159, v189
    s_waitcnt vmcnt(8)
    s_barrier
    ds_read_b128 v[104:107], v80 offset:49152
    ds_read_b128 v[108:111], v81 offset:49152
    ds_read_b128 v[112:115], v82 offset:49152
    ds_read_b128 v[116:119], v83 offset:49152
    v_lshlrev_b32 v1, 1, v3
    v_xor_b32 v1, v4, v1
    v_lshlrev_b32 v1, 4, v1
    v_lshl_add_u32 v1, v3, 8, v1
    v_add_u32 v1, 114688, v1
    v_xor_b32 v11, 0x80, v1
    ds_read_b128 v[16:19], v1 offset:0
    ds_read_b128 v[20:23], v11 offset:1024
    ds_read_b128 v[24:27], v1 offset:2048
    ds_read_b128 v[28:31], v11 offset:3072
    v_sub_u32 v12, s6, v3
    v_mov_b32 v13, 0x7fff7fff
    v_cmp_lt_i32 vcc, 0, v12
    v_cvt_f32_u32 v14, s4
    s_nop 0
    v_cndmask_b32 v32, 0, v13, vcc
    v_cmp_lt_i32 vcc, 4, v12
    v_sqrt_f32 v14, v14
    s_nop 0
    v_cndmask_b32 v33, 0, v13, vcc
    v_cmp_lt_i32 vcc, 8, v12
    v_cmp_gt_u32 s[24:25], 32, v2
    s_nop 0
    v_cndmask_b32 v34, 0, v13, vcc
    v_cmp_lt_i32 vcc, 12, v12
    v_mul_f32 v14, 0x3ec00000, v14
    s_nop 0
    v_cndmask_b32 v35, 0, v13, vcc
    s_waitcnt lgkmcnt(0)
    v_and_b32 v16, v32, v16
    v_and_b32 v17, v32, v17
    v_and_b32 v18, v32, v18
    v_and_b32 v19, v32, v19
    v_and_b32 v20, v33, v20
    v_and_b32 v21, v33, v21
    v_and_b32 v22, v33, v22
    v_and_b32 v23, v33, v23
    v_and_b32 v24, v34, v24
    v_and_b32 v25, v34, v25
    v_and_b32 v26, v34, v26
    v_and_b32 v27, v34, v27
    v_and_b32 v28, v35, v28
    v_and_b32 v29, v35, v29
    v_and_b32 v30, v35, v30
    v_and_b32 v31, v35, v31
    v_pk_max_u16 v16, v16, v20
    v_pk_max_u16 v24, v24, v28
    v_pk_max_u16 v17, v17, v21
    v_pk_max_u16 v25, v25, v29
    v_pk_max_u16 v18, v18, v22
    v_pk_max_u16 v26, v26, v30
    v_pk_max_u16 v19, v19, v23
    v_pk_max_u16 v27, v27, v31
    v_pk_max_u16 v16, v16, v24
    v_pk_max_u16 v17, v17, v25
    v_pk_max_u16 v18, v18, v26
    v_pk_max_u16 v19, v19, v27
    v_pk_min_u16 v16, v16, v17
    v_pk_min_u16 v18, v18, v19
    v_pk_min_u16 v12, v16, v18
    v_lshlrev_b32 v13, 16, v12
    v_and_b32 v12, 0xffff0000, v12
    v_min_u32 v12, v12, v13
    s_nop 1
    v_min_u32_dpp v12, v12, v12 row_ror:8 row_mask:0xf bank_mask:0xf
    s_nop 1
    v_min_u32_dpp v12, v12, v12 row_ror:4 row_mask:0xf bank_mask:0xf
    s_nop 1
    v_min_u32_dpp v12, v12, v12 row_ror:2 row_mask:0xf bank_mask:0xf
    s_nop 1
    v_min_u32_dpp v12, v12, v12 row_ror:1 row_mask:0xf bank_mask:0xf
    v_mov_b32 v13, v12
    s_nop 1
    v_permlane32_swap_b32 v12, v13
    v_min_u32 v12, v12, v13
    v_mov_b32 v13, v12
    s_nop 1
    v_permlane16_swap_b32 v12, v13
    v_min_u32 v12, v12, v13
    v_cmp_gt_u32 vcc, 0x70000000, v12
    v_mul_f32 v12, v12, v14
    v_and_b32 v12, 0x7f800000, v12
    v_or_b32 v12, 0x400000, v12
    v_cndmask_b32 v12, 0, v12, vcc
    v_accvgpr_write_b32 a228, v12
    v_lshrrev_b32 v13, 16, v12
    v_cndmask_b32 v13, 0, v13, s[24:25]
    v_accvgpr_write_b32 a224, v13
    s_waitcnt lgkmcnt(0)
    s_nop 0
    v_mfma_f32_16x16x32_bf16 v[16:19], v[104:107], a[128:131], 0
    ds_read_b64_tr_b16 a[64:65], v84 offset:49152
    ds_read_b64_tr_b16 a[66:67], v84 offset:53248
    v_mfma_f32_16x16x32_bf16 v[16:19], v[108:111], a[132:135], v[16:19]
    ds_read_b64_tr_b16 a[72:73], v85 offset:49152
    ds_read_b64_tr_b16 a[74:75], v85 offset:53248
    v_mfma_f32_16x16x32_bf16 v[16:19], v[112:115], a[136:139], v[16:19]
    ds_read_b64_tr_b16 a[80:81], v86 offset:49152
    ds_read_b64_tr_b16 a[82:83], v86 offset:53248
    v_mfma_f32_16x16x32_bf16 v[16:19], v[116:119], a[140:143], v[16:19]
    ds_read_b64_tr_b16 a[88:89], v87 offset:49152
    ds_read_b64_tr_b16 a[90:91], v87 offset:53248
    v_mfma_f32_16x16x32_bf16 v[32:35], v[104:107], a[144:147], 0
    ds_read_b64_tr_b16 a[96:97], v88 offset:49152
    ds_read_b64_tr_b16 a[98:99], v88 offset:53248
    v_mfma_f32_16x16x32_bf16 v[32:35], v[108:111], a[148:151], v[32:35]
    s_waitcnt lgkmcnt(6)
    ds_read_b64_tr_b16 a[104:105], v89 offset:49152
    ds_read_b64_tr_b16 a[106:107], v89 offset:53248
    v_mfma_f32_16x16x32_bf16 v[32:35], v[112:115], a[152:155], v[32:35]
    ds_read_b64_tr_b16 a[112:113], v90 offset:49152
    ds_read_b64_tr_b16 a[114:115], v90 offset:53248
    v_mfma_f32_16x16x32_bf16 v[32:35], v[116:119], a[156:159], v[32:35]
    ds_read_b64_tr_b16 a[120:121], v91 offset:49152
    ds_read_b64_tr_b16 a[122:123], v91 offset:53248
    v_cndmask_b32 v16, v102, v16, s[60:61]
    v_cndmask_b32 v17, v102, v17, s[62:63]
    v_cndmask_b32 v18, v102, v18, s[64:65]
    v_cndmask_b32 v19, v102, v19, s[66:67]
    v_max3_f32 v12, v16, v17, v18
    v_max_f32 v12, v12, v19
    v_cndmask_b32 v32, v102, v32, s[60:61]
    v_cndmask_b32 v33, v102, v33, s[62:63]
    v_cndmask_b32 v34, v102, v34, s[64:65]
    v_cndmask_b32 v35, v102, v35, s[66:67]
    v_max3_f32 v14, v32, v33, v34
    v_max_f32 v14, v14, v35
    s_cmp_gt_u32 s6, 16
    s_cbranch_scc1 L_fa01_0_more
L_fa01_0:
    v_mov_b32 v13, v12
    v_mov_b32 v15, v14
    v_mfma_f32_32x32x16_bf16 v[128:143], a[208:211], a[224:227], 0
    v_permlane32_swap_b32 v12, v13
    v_permlane32_swap_b32 v14, v15
    v_max_f32 v12, v12, v13
    v_max_f32 v14, v14, v15
    v_mov_b32 v13, v12
    v_mov_b32 v15, v14
    v_mfma_f32_32x32x16_bf16 v[144:159], a[208:211], a[224:227], 0
    v_permlane16_swap_b32 v12, v13
    v_permlane16_swap_b32 v14, v15
    v_max_f32 v12, v12, v13
    v_max_f32 v14, v14, v15
    v_add_f32 v12, 0x40800000, v12
    v_add_f32 v14, 0x40800000, v14
    v_sub_f32 v64, 0, v12
    v_sub_f32 v65, 0, v12
    v_sub_f32 v66, 0, v12
    v_sub_f32 v67, 0, v12
    v_mfma_f32_32x32x16_bf16 v[160:175], a[208:211], a[224:227], 0
    v_sub_f32 v68, 0, v14
    v_sub_f32 v69, 0, v14
    v_sub_f32 v70, 0, v14
    v_sub_f32 v71, 0, v14
    v_mfma_f32_32x32x16_bf16 v[176:191], a[208:211], a[224:227], 0
    v_sub_f32 v16, v16, v12
    v_sub_f32 v17, v17, v12
    v_sub_f32 v18, v18, v12
    v_sub_f32 v19, v19, v12
    v_exp_f32 v16, v16
    v_exp_f32 v17, v17
    v_exp_f32 v18, v18
    v_exp_f32 v19, v19
    v_sub_f32 v32, v32, v14
    v_sub_f32 v33, v33, v14
    v_sub_f32 v34, v34, v14
    v_sub_f32 v35, v35, v14
    v_exp_f32 v32, v32
    v_exp_f32 v33, v33
    v_exp_f32 v34, v34
    v_exp_f32 v35, v35
    v_cvt_pk_bf16_f32 v48, v16, v17
    v_cvt_pk_bf16_f32 v49, v18, v19
    v_cvt_pk_bf16_f32 v56, v32, v33
    v_cvt_pk_bf16_f32 v57, v34, v35
    s_cmp_gt_u32 s6, 16
    s_cbranch_scc1 L_fb01_0_more
L_fb01_0:
    s_waitcnt lgkmcnt(0)
    s_nop 0
    v_smfmac_f32_16x16x64_bf16 a[192:195], a[208:211], v[48:55], v101
    ds_read_b64_tr_b16 a[68:69], v84 offset:57344
    ds_read_b64_tr_b16 a[70:71], v84 offset:61440
    v_mfma_f32_16x16x32_bf16 v[128:131], a[64:67], v[48:51], v[128:131]
    s_add_u32 s40, s18, s11
    s_addc_u32 s41, s19, 0
    s_add_u32 m0, s12, 0
    s_nop 0
    global_load_lds_dwordx4 v92, s[40:41]
    v_mfma_f32_16x16x32_bf16 v[132:135], a[72:75], v[48:51], v[132:135]
    ds_read_b64_tr_b16 a[76:77], v85 offset:57344
    ds_read_b64_tr_b16 a[78:79], v85 offset:61440
    v_mfma_f32_16x16x32_bf16 v[136:139], a[80:83], v[48:51], v[136:139]
    global_load_lds_dwordx4 v93, s[40:41] offset:1024
    v_mfma_f32_16x16x32_bf16 v[140:143], a[88:91], v[48:51], v[140:143]
    ds_read_b64_tr_b16 a[84:85], v86 offset:57344
    ds_read_b64_tr_b16 a[86:87], v86 offset:61440
    v_mfma_f32_16x16x32_bf16 v[144:147], a[96:99], v[48:51], v[144:147]
    ds_read_b64_tr_b16 a[92:93], v87 offset:57344
    ds_read_b64_tr_b16 a[94:95], v87 offset:61440
    v_mfma_f32_16x16x32_bf16 v[148:151], a[104:107], v[48:51], v[148:151]
    global_load_lds_dwordx4 v94, s[40:41] offset:2048
    v_mfma_f32_16x16x32_bf16 v[152:155], a[112:115], v[48:51], v[152:155]
    ds_read_b64_tr_b16 a[100:101], v88 offset:57344
    ds_read_b64_tr_b16 a[102:103], v88 offset:61440
    v_mfma_f32_16x16x32_bf16 v[156:159], a[120:123], v[48:51], v[156:159]
    global_load_lds_dwordx4 v95, s[40:41] offset:3072
    v_smfmac_f32_16x16x64_bf16 a[196:199], a[208:211], v[56:63], v101
    ds_read_b64_tr_b16 a[108:109], v89 offset:57344
    ds_read_b64_tr_b16 a[110:111], v89 offset:61440
    v_mfma_f32_16x16x32_bf16 v[160:163], a[64:67], v[56:59], v[160:163]
    ds_read_b64_tr_b16 a[116:117], v90 offset:57344
    ds_read_b64_tr_b16 a[118:119], v90 offset:61440
    v_mfma_f32_16x16x32_bf16 v[164:167], a[72:75], v[56:59], v[164:167]
    s_add_u32 s42, s20, s11
    s_addc_u32 s43, s21, 0
    s_add_u32 m0, s13, 0
    s_nop 0
    global_load_lds_dwordx4 v96, s[42:43]
    v_mfma_f32_16x16x32_bf16 v[168:171], a[80:83], v[56:59], v[168:171]
    ds_read_b64_tr_b16 a[124:125], v91 offset:57344
    ds_read_b64_tr_b16 a[126:127], v91 offset:61440
    v_mfma_f32_16x16x32_bf16 v[172:175], a[88:91], v[56:59], v[172:175]
    global_load_lds_dwordx4 v97, s[42:43] offset:1024
    v_mfma_f32_16x16x32_bf16 v[176:179], a[96:99], v[56:59], v[176:179]
    v_mfma_f32_16x16x32_bf16 v[180:183], a[104:107], v[56:59], v[180:183]
    global_load_lds_dwordx4 v98, s[42:43] offset:2048
    v_mfma_f32_16x16x32_bf16 v[184:187], a[112:115], v[56:59], v[184:187]
    v_mfma_f32_16x16x32_bf16 v[188:191], a[120:123], v[56:59], v[188:191]
    global_load_lds_dwordx4 v99, s[42:43] offset:3072
    s_cmp_gt_u32 s6, 32
    s_cbranch_scc1 L_fc01_0_more
L_fc01_0:
    s_waitcnt vmcnt(12)
    ds_read_b128 v[16:19], v120 offset:32768
    ds_read_b128 v[20:23], v120 offset:32768
    ds_read_b128 v[24:27], v121 offset:32768
    ds_read_b128 v[28:31], v121 offset:32768
    ds_read_b128 v[32:35], v122 offset:32768
    ds_read_b128 v[36:39], v122 offset:32768
    ds_read_b128 v[40:43], v123 offset:32768
    ds_read_b128 v[44:47], v123 offset:32768
    s_waitcnt lgkmcnt(6)
    v_smfmac_f32_16x16x64_bf16 v[192:195], a[216:219], v[16:23], v0
    s_add_u32 s40, s18, s44
    s_addc_u32 s41, s19, 0
    s_add_u32 m0, s12, 16384
    s_nop 0
    global_load_lds_dwordx4 v92, s[40:41]
    v_smfmac_f32_16x16x64_bf16 v[196:199], a[220:223], v[16:23], v0
    s_waitcnt vmcnt(9)
    ds_read_b128 v[16:19], v124 offset:32768
    ds_read_b128 v[20:23], v124 offset:32768
    s_waitcnt lgkmcnt(6)
    v_smfmac_f32_16x16x64_bf16 v[200:203], a[216:219], v[24:31], v0
    global_load_lds_dwordx4 v93, s[40:41] offset:1024
    s_nop 4
    v_cvt_pk_bf16_f32 v192, v192, v193
    v_cvt_pk_bf16_f32 v193, v194, v195
    v_accvgpr_write_b32 a160, v192
    v_accvgpr_write_b32 a161, v193
    v_smfmac_f32_16x16x64_bf16 v[204:207], a[220:223], v[24:31], v0
    ds_read_b128 v[24:27], v125 offset:32768
    ds_read_b128 v[28:31], v125 offset:32768
    v_cvt_pk_bf16_f32 v196, v196, v197
    v_cvt_pk_bf16_f32 v197, v198, v199
    v_accvgpr_write_b32 a162, v196
    v_accvgpr_write_b32 a163, v197
    s_waitcnt lgkmcnt(6)
    v_smfmac_f32_16x16x64_bf16 v[208:211], a[216:219], v[32:39], v0
    global_load_lds_dwordx4 v94, s[40:41] offset:2048
    v_cvt_pk_bf16_f32 v200, v200, v201
    v_cvt_pk_bf16_f32 v201, v202, v203
    v_accvgpr_write_b32 a164, v200
    v_accvgpr_write_b32 a165, v201
    v_smfmac_f32_16x16x64_bf16 v[212:215], a[220:223], v[32:39], v0
    ds_read_b128 v[32:35], v126 offset:32768
    ds_read_b128 v[36:39], v126 offset:32768
    v_cvt_pk_bf16_f32 v204, v204, v205
    v_cvt_pk_bf16_f32 v205, v206, v207
    v_accvgpr_write_b32 a166, v204
    v_accvgpr_write_b32 a167, v205
    s_waitcnt lgkmcnt(6)
    v_smfmac_f32_16x16x64_bf16 v[216:219], a[216:219], v[40:47], v0
    global_load_lds_dwordx4 v95, s[40:41] offset:3072
    v_cvt_pk_bf16_f32 v208, v208, v209
    v_cvt_pk_bf16_f32 v209, v210, v211
    v_accvgpr_write_b32 a168, v208
    v_accvgpr_write_b32 a169, v209
    v_smfmac_f32_16x16x64_bf16 v[220:223], a[220:223], v[40:47], v0
    ds_read_b128 v[40:43], v127 offset:32768
    ds_read_b128 v[44:47], v127 offset:32768
    v_cvt_pk_bf16_f32 v212, v212, v213
    v_cvt_pk_bf16_f32 v213, v214, v215
    v_accvgpr_write_b32 a170, v212
    v_accvgpr_write_b32 a171, v213
    s_waitcnt lgkmcnt(6)
    v_smfmac_f32_16x16x64_bf16 v[224:227], a[216:219], v[16:23], v0
    s_add_u32 s42, s20, s44
    s_addc_u32 s43, s21, 0
    s_add_u32 m0, s13, 16384
    s_nop 0
    global_load_lds_dwordx4 v96, s[42:43]
    v_cvt_pk_bf16_f32 v216, v216, v217
    v_cvt_pk_bf16_f32 v217, v218, v219
    v_accvgpr_write_b32 a172, v216
    v_accvgpr_write_b32 a173, v217
    v_smfmac_f32_16x16x64_bf16 v[228:231], a[220:223], v[16:23], v0
    v_cvt_pk_bf16_f32 v220, v220, v221
    v_cvt_pk_bf16_f32 v221, v222, v223
    v_accvgpr_write_b32 a174, v220
    v_accvgpr_write_b32 a175, v221
    s_waitcnt lgkmcnt(4)
    v_smfmac_f32_16x16x64_bf16 v[232:235], a[216:219], v[24:31], v0
    global_load_lds_dwordx4 v97, s[42:43] offset:1024
    v_cvt_pk_bf16_f32 v224, v224, v225
    v_cvt_pk_bf16_f32 v225, v226, v227
    v_accvgpr_write_b32 a176, v224
    v_accvgpr_write_b32 a177, v225
    v_smfmac_f32_16x16x64_bf16 v[236:239], a[220:223], v[24:31], v0
    v_cvt_pk_bf16_f32 v228, v228, v229
    v_cvt_pk_bf16_f32 v229, v230, v231
    v_accvgpr_write_b32 a178, v228
    v_accvgpr_write_b32 a179, v229
    s_waitcnt lgkmcnt(2)
    v_smfmac_f32_16x16x64_bf16 v[240:243], a[216:219], v[32:39], v0
    global_load_lds_dwordx4 v98, s[42:43] offset:2048
    v_cvt_pk_bf16_f32 v232, v232, v233
    v_cvt_pk_bf16_f32 v233, v234, v235
    v_accvgpr_write_b32 a180, v232
    v_accvgpr_write_b32 a181, v233
    v_smfmac_f32_16x16x64_bf16 v[244:247], a[220:223], v[32:39], v0
    v_cvt_pk_bf16_f32 v236, v236, v237
    v_cvt_pk_bf16_f32 v237, v238, v239
    v_accvgpr_write_b32 a182, v236
    v_accvgpr_write_b32 a183, v237
    s_waitcnt lgkmcnt(0)
    v_smfmac_f32_16x16x64_bf16 v[248:251], a[216:219], v[40:47], v0
    global_load_lds_dwordx4 v99, s[42:43] offset:3072
    v_cvt_pk_bf16_f32 v240, v240, v241
    v_cvt_pk_bf16_f32 v241, v242, v243
    v_accvgpr_write_b32 a184, v240
    v_accvgpr_write_b32 a185, v241
    v_smfmac_f32_16x16x64_bf16 v[252:255], a[220:223], v[40:47], v0
    v_cvt_pk_bf16_f32 v244, v244, v245
    v_cvt_pk_bf16_f32 v245, v246, v247
    v_accvgpr_write_b32 a186, v244
    v_accvgpr_write_b32 a187, v245
    s_nop 2
    v_cvt_pk_bf16_f32 v248, v248, v249
    v_cvt_pk_bf16_f32 v249, v250, v251
    v_accvgpr_write_b32 a188, v248
    v_accvgpr_write_b32 a189, v249
    v_cvt_pk_bf16_f32 v252, v252, v253
    v_cvt_pk_bf16_f32 v253, v254, v255
    v_accvgpr_write_b32 a190, v252
    v_accvgpr_write_b32 a191, v253
    s_waitcnt vmcnt(8)
    s_barrier
    ds_read_b128 a[0:3], v80 offset:0
    ds_read_b128 a[4:7], v81 offset:0
    ds_read_b128 a[8:11], v82 offset:0
    ds_read_b128 a[12:15], v83 offset:0
    ds_read_b128 a[16:19], v80 offset:4096
    ds_read_b128 a[20:23], v81 offset:4096
    ds_read_b128 a[24:27], v82 offset:4096
    ds_read_b128 a[28:31], v83 offset:4096
    s_waitcnt lgkmcnt(2)
    ds_read_b128 a[32:35], v80 offset:8192
    ds_read_b128 a[36:39], v81 offset:8192
    ds_read_b128 a[40:43], v82 offset:8192
    ds_read_b128 a[44:47], v83 offset:8192
    ds_read_b128 a[48:51], v80 offset:12288
    ds_read_b128 a[52:55], v81 offset:12288
    ds_read_b128 a[56:59], v82 offset:12288
    ds_read_b128 a[60:63], v83 offset:12288
    v_mov_b32 v44, v102
    v_mov_b32 v45, v102
    v_mov_b32 v46, v102
    v_mov_b32 v47, v102
    s_waitcnt lgkmcnt(0)
    s_nop 0
    v_mfma_f32_16x16x32_bf16 v[16:19], v[104:107], a[160:163], 0
    v_mfma_f32_16x16x32_bf16 v[16:19], v[108:111], a[164:167], v[16:19]
    v_mfma_f32_16x16x32_bf16 v[16:19], v[112:115], a[168:171], v[16:19]
    v_mfma_f32_16x16x32_bf16 v[16:19], v[116:119], a[172:175], v[16:19]
    v_mfma_f32_16x16x32_bf16 v[32:35], v[104:107], a[176:179], 0
    v_mfma_f32_16x16x32_bf16 v[32:35], v[108:111], a[180:183], v[32:35]
    v_mfma_f32_16x16x32_bf16 v[32:35], v[112:115], a[184:187], v[32:35]
    v_mfma_f32_16x16x32_bf16 v[32:35], v[116:119], a[188:191], v[32:35]
    s_nop 3
    v_cndmask_b32 v16, v102, v16, s[60:61]
    v_cndmask_b32 v17, v102, v17, s[62:63]
    v_cndmask_b32 v18, v102, v18, s[64:65]
    v_cndmask_b32 v19, v102, v19, s[66:67]
    v_max3_f32 v12, v16, v17, v18
    v_max_f32 v12, v12, v19
    v_cndmask_b32 v32, v102, v32, s[60:61]
    v_cndmask_b32 v33, v102, v33, s[62:63]
    v_cndmask_b32 v34, v102, v34, s[64:65]
    v_cndmask_b32 v35, v102, v35, s[66:67]
    v_max3_f32 v14, v32, v33, v34
    v_max_f32 v14, v14, v35
    s_cmp_gt_u32 s6, 16
    s_cbranch_scc1 L_fa23_0_more
L_fa23_0:
    v_mov_b32 v13, v12
    v_mov_b32 v15, v14
    v_mfma_f32_32x32x16_bf16 v[192:207], a[208:211], a[224:227], 0
    v_permlane32_swap_b32 v12, v13
    v_permlane32_swap_b32 v14, v15
    v_max_f32 v12, v12, v13
    v_max_f32 v14, v14, v15
    v_mov_b32 v13, v12
    v_mov_b32 v15, v14
    v_mfma_f32_32x32x16_bf16 v[208:223], a[208:211], a[224:227], 0
    v_permlane16_swap_b32 v12, v13
    v_permlane16_swap_b32 v14, v15
    v_max_f32 v12, v12, v13
    v_max_f32 v14, v14, v15
    v_add_f32 v12, 0x40800000, v12
    v_add_f32 v14, 0x40800000, v14
    v_sub_f32 v72, 0, v12
    v_sub_f32 v73, 0, v12
    v_sub_f32 v74, 0, v12
    v_sub_f32 v75, 0, v12
    v_mfma_f32_32x32x16_bf16 v[224:239], a[208:211], a[224:227], 0
    v_sub_f32 v76, 0, v14
    v_sub_f32 v77, 0, v14
    v_sub_f32 v78, 0, v14
    v_sub_f32 v79, 0, v14
    v_mfma_f32_32x32x16_bf16 v[240:255], a[208:211], a[224:227], 0
    v_sub_f32 v16, v16, v12
    v_sub_f32 v17, v17, v12
    v_sub_f32 v18, v18, v12
    v_sub_f32 v19, v19, v12
    v_exp_f32 v16, v16
    v_exp_f32 v17, v17
    v_exp_f32 v18, v18
    v_exp_f32 v19, v19
    v_sub_f32 v32, v32, v14
    v_sub_f32 v33, v33, v14
    v_sub_f32 v34, v34, v14
    v_sub_f32 v35, v35, v14
    v_exp_f32 v32, v32
    v_exp_f32 v33, v33
    v_exp_f32 v34, v34
    v_exp_f32 v35, v35
    v_cvt_pk_bf16_f32 v48, v16, v17
    v_cvt_pk_bf16_f32 v49, v18, v19
    v_cvt_pk_bf16_f32 v56, v32, v33
    v_cvt_pk_bf16_f32 v57, v34, v35
    s_cmp_gt_u32 s6, 16
    s_cbranch_scc1 L_fb23_0_more
L_fb23_0:
    s_waitcnt lgkmcnt(0)
    s_nop 0
    v_smfmac_f32_16x16x64_bf16 a[200:203], a[208:211], v[48:55], v101
    v_mfma_f32_16x16x32_bf16 v[192:195], a[64:67], v[48:51], v[192:195]
    s_add_u32 s40, s18, s10
    s_addc_u32 s41, s19, 0
    s_add_u32 m0, s12, 32768
    s_nop 0
    global_load_lds_dwordx4 v92, s[40:41]
    v_mfma_f32_16x16x32_bf16 v[196:199], a[72:75], v[48:51], v[196:199]
    v_mfma_f32_16x16x32_bf16 v[200:203], a[80:83], v[48:51], v[200:203]
    global_load_lds_dwordx4 v93, s[40:41] offset:1024
    v_mfma_f32_16x16x32_bf16 v[204:207], a[88:91], v[48:51], v[204:207]
    v_mfma_f32_16x16x32_bf16 v[208:211], a[96:99], v[48:51], v[208:211]
    global_load_lds_dwordx4 v94, s[40:41] offset:2048
    v_mfma_f32_16x16x32_bf16 v[212:215], a[104:107], v[48:51], v[212:215]
    v_mfma_f32_16x16x32_bf16 v[216:219], a[112:115], v[48:51], v[216:219]
    global_load_lds_dwordx4 v95, s[40:41] offset:3072
    v_mfma_f32_16x16x32_bf16 v[220:223], a[120:123], v[48:51], v[220:223]
    s_cmp_gt_u32 s6, 32
    s_cbranch_scc1 L_fc2_0_more
L_fc2_0:
    s_add_u32 s42, s20, s10
    s_addc_u32 s43, s21, 0
L_join:
    s_mov_b32 s33, 0
    s_waitcnt lgkmcnt(0)
    s_cmp_le_u32 s5, 2
    s_cbranch_scc1 L_short
L_loop:
    v_mfma_f32_16x16x32_bf16 v[16:19], a[0:3], a[128:131], v[64:67]
    v_exp_f32 v44, v44
    v_mfma_f32_16x16x32_bf16 v[16:19], a[4:7], a[132:135], v[16:19]
    s_add_u32 m0, s13, 32768
    v_exp_f32 v45, v45
    v_mfma_f32_16x16x32_bf16 v[16:19], a[8:11], a[136:139], v[16:19]
    v_cvt_pk_bf16_f32 v62, v44, v45
    v_mfma_f32_16x16x32_bf16 v[16:19], a[12:15], a[140:143], v[16:19]
    global_load_lds_dwordx4 v96, s[42:43]
    v_mfma_f32_16x16x32_bf16 v[20:23], a[28:31], a[140:143], v[64:67]
    v_exp_f32 v46, v46
    v_mfma_f32_16x16x32_bf16 v[20:23], a[24:27], a[136:139], v[20:23]
    v_exp_f32 v47, v47
    v_mfma_f32_16x16x32_bf16 v[20:23], a[20:23], a[132:135], v[20:23]
    v_cvt_pk_bf16_f32 v63, v46, v47
    v_mfma_f32_16x16x32_bf16 v[20:23], a[16:19], a[128:131], v[20:23]
    global_load_lds_dwordx4 v97, s[42:43] offset:1024
    v_mfma_f32_16x16x32_bf16 v[24:27], a[32:35], a[128:131], v[64:67]
    v_exp_f32 v16, v16
    v_mfma_f32_16x16x32_bf16 v[24:27], a[36:39], a[132:135], v[24:27]
    v_exp_f32 v17, v17
    v_mfma_f32_16x16x32_bf16 v[24:27], a[40:43], a[136:139], v[24:27]
    v_cvt_pk_bf16_f32 v48, v16, v17
    v_mfma_f32_16x16x32_bf16 v[24:27], a[44:47], a[140:143], v[24:27]
    global_load_lds_dwordx4 v98, s[42:43] offset:2048
    v_mfma_f32_16x16x32_bf16 v[28:31], a[60:63], a[140:143], v[64:67]
    v_exp_f32 v18, v18
    v_mfma_f32_16x16x32_bf16 v[28:31], a[56:59], a[136:139], v[28:31]
    v_exp_f32 v19, v19
    v_mfma_f32_16x16x32_bf16 v[28:31], a[52:55], a[132:135], v[28:31]
    v_exp_f32 v20, v20
    v_mfma_f32_16x16x32_bf16 v[28:31], a[48:51], a[128:131], v[28:31]
    v_cvt_pk_bf16_f32 v49, v18, v19
    v_smfmac_f32_16x16x64_bf16 a[204:207], a[208:211], v[56:63], v101
    global_load_lds_dwordx4 v99, s[42:43] offset:3072
    v_mfma_f32_16x16x32_bf16 v[224:227], a[64:67], v[56:59], v[224:227]
    v_exp_f32 v21, v21
    v_mfma_f32_16x16x32_bf16 v[224:227], a[68:71], v[60:63], v[224:227]
    ds_read_b64_tr_b16 a[64:65], v84 offset:0
    v_cvt_pk_bf16_f32 v50, v20, v21
    v_mfma_f32_16x16x32_bf16 v[228:231], a[76:79], v[60:63], v[228:231]
    ds_read_b64_tr_b16 a[66:67], v84 offset:4096
    ds_read_b64_tr_b16 a[68:69], v84 offset:8192
    v_mfma_f32_16x16x32_bf16 v[228:231], a[72:75], v[56:59], v[228:231]
    v_exp_f32 v22, v22
    v_mfma_f32_16x16x32_bf16 v[232:235], a[80:83], v[56:59], v[232:235]
    ds_read_b64_tr_b16 a[70:71], v84 offset:12288
    ds_read_b64_tr_b16 a[76:77], v85 offset:8192
    v_mfma_f32_16x16x32_bf16 v[232:235], a[84:87], v[60:63], v[232:235]
    v_exp_f32 v23, v23
    v_mfma_f32_16x16x32_bf16 v[236:239], a[92:95], v[60:63], v[236:239]
    ds_read_b64_tr_b16 a[78:79], v85 offset:12288
    v_cvt_pk_bf16_f32 v51, v22, v23
    v_mfma_f32_16x16x32_bf16 v[236:239], a[88:91], v[56:59], v[236:239]
    ds_read_b64_tr_b16 a[72:73], v85 offset:0
    ds_read_b64_tr_b16 a[74:75], v85 offset:4096
    v_mfma_f32_16x16x32_bf16 v[240:243], a[96:99], v[56:59], v[240:243]
    v_exp_f32 v24, v24
    v_mfma_f32_16x16x32_bf16 v[240:243], a[100:103], v[60:63], v[240:243]
    ds_read_b64_tr_b16 a[80:81], v86 offset:0
    ds_read_b64_tr_b16 a[82:83], v86 offset:4096
    v_mfma_f32_16x16x32_bf16 v[244:247], a[108:111], v[60:63], v[244:247]
    v_exp_f32 v25, v25
    v_mfma_f32_16x16x32_bf16 v[244:247], a[104:107], v[56:59], v[244:247]
    ds_read_b64_tr_b16 a[84:85], v86 offset:8192
    v_cvt_pk_bf16_f32 v52, v24, v25
    v_mfma_f32_16x16x32_bf16 v[248:251], a[112:115], v[56:59], v[248:251]
    ds_read_b64_tr_b16 a[86:87], v86 offset:12288
    ds_read_b64_tr_b16 a[92:93], v87 offset:8192
    v_mfma_f32_16x16x32_bf16 v[248:251], a[116:119], v[60:63], v[248:251]
    v_exp_f32 v26, v26
    v_mfma_f32_16x16x32_bf16 v[252:255], a[124:127], v[60:63], v[252:255]
    ds_read_b64_tr_b16 a[94:95], v87 offset:12288
    ds_read_b64_tr_b16 a[88:89], v87 offset:0
    v_mfma_f32_16x16x32_bf16 v[252:255], a[120:123], v[56:59], v[252:255]
    v_exp_f32 v27, v27
    v_mfma_f32_16x16x32_bf16 v[32:35], a[0:3], a[144:147], v[68:71]
    ds_read_b64_tr_b16 a[90:91], v87 offset:4096
    v_cvt_pk_bf16_f32 v53, v26, v27
    v_mfma_f32_16x16x32_bf16 v[32:35], a[4:7], a[148:151], v[32:35]
    ds_read_b64_tr_b16 a[96:97], v88 offset:0
    ds_read_b64_tr_b16 a[98:99], v88 offset:4096
    v_mfma_f32_16x16x32_bf16 v[32:35], a[8:11], a[152:155], v[32:35]
    v_exp_f32 v28, v28
    v_mfma_f32_16x16x32_bf16 v[32:35], a[12:15], a[156:159], v[32:35]
    ds_read_b64_tr_b16 a[100:101], v88 offset:8192
    ds_read_b64_tr_b16 a[102:103], v88 offset:12288
    v_mfma_f32_16x16x32_bf16 v[36:39], a[28:31], a[156:159], v[68:71]
    v_exp_f32 v29, v29
    v_mfma_f32_16x16x32_bf16 v[36:39], a[24:27], a[152:155], v[36:39]
    ds_read_b64_tr_b16 a[108:109], v89 offset:8192
    v_cvt_pk_bf16_f32 v54, v28, v29
    v_mfma_f32_16x16x32_bf16 v[36:39], a[20:23], a[148:151], v[36:39]
    ds_read_b64_tr_b16 a[110:111], v89 offset:12288
    ds_read_b64_tr_b16 a[104:105], v89 offset:0
    v_mfma_f32_16x16x32_bf16 v[36:39], a[16:19], a[144:147], v[36:39]
    v_exp_f32 v30, v30
    v_mfma_f32_16x16x32_bf16 v[40:43], a[32:35], a[144:147], v[68:71]
    ds_read_b64_tr_b16 a[106:107], v89 offset:4096
    ds_read_b64_tr_b16 a[112:113], v90 offset:0
    v_mfma_f32_16x16x32_bf16 v[40:43], a[36:39], a[148:151], v[40:43]
    v_exp_f32 v31, v31
    v_mfma_f32_16x16x32_bf16 v[40:43], a[40:43], a[152:155], v[40:43]
    ds_read_b64_tr_b16 a[114:115], v90 offset:4096
    v_cvt_pk_bf16_f32 v55, v30, v31
    v_mfma_f32_16x16x32_bf16 v[40:43], a[44:47], a[156:159], v[40:43]
    ds_read_b64_tr_b16 a[116:117], v90 offset:8192
    ds_read_b64_tr_b16 a[118:119], v90 offset:12288
    v_mfma_f32_16x16x32_bf16 v[44:47], a[60:63], a[156:159], v[68:71]
    v_exp_f32 v32, v32
    v_mfma_f32_16x16x32_bf16 v[44:47], a[56:59], a[152:155], v[44:47]
    ds_read_b64_tr_b16 a[124:125], v91 offset:8192
    ds_read_b64_tr_b16 a[126:127], v91 offset:12288
    v_mfma_f32_16x16x32_bf16 v[44:47], a[52:55], a[148:151], v[44:47]
    v_exp_f32 v33, v33
    v_mfma_f32_16x16x32_bf16 v[44:47], a[48:51], a[144:147], v[44:47]
    ds_read_b64_tr_b16 a[120:121], v91 offset:0
    v_cvt_pk_bf16_f32 v56, v32, v33
    v_smfmac_f32_16x16x64_bf16 a[192:195], a[208:211], v[48:55], v101
    s_waitcnt lgkmcnt(7)
    ds_read_b64_tr_b16 a[122:123], v91 offset:4096
    v_mfma_f32_16x16x32_bf16 v[128:131], a[64:67], v[48:51], v[128:131]
    v_exp_f32 v34, v34
    v_mfma_f32_16x16x32_bf16 v[128:131], a[68:71], v[52:55], v[128:131]
    v_exp_f32 v35, v35
    v_mfma_f32_16x16x32_bf16 v[132:135], a[76:79], v[52:55], v[132:135]
    v_cvt_pk_bf16_f32 v57, v34, v35
    v_readlane_b32 s10, v100, s8
    v_mfma_f32_16x16x32_bf16 v[132:135], a[72:75], v[48:51], v[132:135]
    v_exp_f32 v36, v36
    v_mfma_f32_16x16x32_bf16 v[136:139], a[80:83], v[48:51], v[136:139]
    v_exp_f32 v37, v37
    v_mfma_f32_16x16x32_bf16 v[136:139], a[84:87], v[52:55], v[136:139]
    s_add_u32 s40, s18, s10
    v_cvt_pk_bf16_f32 v58, v36, v37
    v_mfma_f32_16x16x32_bf16 v[140:143], a[92:95], v[52:55], v[140:143]
    s_addc_u32 s41, s19, 0
    v_exp_f32 v38, v38
    v_mfma_f32_16x16x32_bf16 v[140:143], a[88:91], v[48:51], v[140:143]
    s_waitcnt vmcnt(8) lgkmcnt(0)
    v_exp_f32 v39, v39
    v_mfma_f32_16x16x32_bf16 v[144:147], a[96:99], v[48:51], v[144:147]
    s_barrier
    v_mfma_f32_16x16x32_bf16 v[144:147], a[100:103], v[52:55], v[144:147]
    s_add_u32 m0, s12, 0
    v_cvt_pk_bf16_f32 v59, v38, v39
    v_mfma_f32_16x16x32_bf16 v[148:151], a[108:111], v[52:55], v[148:151]
    global_load_lds_dwordx4 v92, s[40:41]
    v_mfma_f32_16x16x32_bf16 v[148:151], a[104:107], v[48:51], v[148:151]
    s_add_u32 s42, s20, s10
    v_exp_f32 v40, v40
    v_mfma_f32_16x16x32_bf16 v[152:155], a[112:115], v[48:51], v[152:155]
    s_addc_u32 s43, s21, 0
    v_exp_f32 v41, v41
    v_mfma_f32_16x16x32_bf16 v[152:155], a[116:119], v[52:55], v[152:155]
    s_add_u32 s8, s8, 1
    v_cvt_pk_bf16_f32 v60, v40, v41
    v_mfma_f32_16x16x32_bf16 v[156:159], a[124:127], v[52:55], v[156:159]
    s_cmp_eq_u32 s8, s9
    v_exp_f32 v42, v42
    v_mfma_f32_16x16x32_bf16 v[156:159], a[120:123], v[48:51], v[156:159]
    v_exp_f32 v43, v43
    v_mfma_f32_16x16x32_bf16 v[16:19], a[0:3], a[160:163], v[72:75]
    s_mov_b32 s33, 16384
    v_cvt_pk_bf16_f32 v61, v42, v43
    v_mfma_f32_16x16x32_bf16 v[16:19], a[4:7], a[164:167], v[16:19]
    global_load_lds_dwordx4 v93, s[40:41] offset:1024
    v_mfma_f32_16x16x32_bf16 v[16:19], a[8:11], a[168:171], v[16:19]
    v_exp_f32 v44, v44
    v_mfma_f32_16x16x32_bf16 v[16:19], a[12:15], a[172:175], v[16:19]
    v_exp_f32 v45, v45
    v_mfma_f32_16x16x32_bf16 v[20:23], a[28:31], a[172:175], v[72:75]
    v_cvt_pk_bf16_f32 v62, v44, v45
    v_mfma_f32_16x16x32_bf16 v[20:23], a[24:27], a[168:171], v[20:23]
    v_exp_f32 v46, v46
    v_mfma_f32_16x16x32_bf16 v[20:23], a[20:23], a[164:167], v[20:23]
    v_exp_f32 v47, v47
    v_mfma_f32_16x16x32_bf16 v[20:23], a[16:19], a[160:163], v[20:23]
    v_cvt_pk_bf16_f32 v63, v46, v47
    v_mfma_f32_16x16x32_bf16 v[24:27], a[32:35], a[160:163], v[72:75]
    global_load_lds_dwordx4 v94, s[40:41] offset:2048
    v_mfma_f32_16x16x32_bf16 v[24:27], a[36:39], a[164:167], v[24:27]
    v_exp_f32 v16, v16
    v_mfma_f32_16x16x32_bf16 v[24:27], a[40:43], a[168:171], v[24:27]
    v_exp_f32 v17, v17
    v_mfma_f32_16x16x32_bf16 v[24:27], a[44:47], a[172:175], v[24:27]
    v_cvt_pk_bf16_f32 v48, v16, v17
    v_mfma_f32_16x16x32_bf16 v[28:31], a[60:63], a[172:175], v[72:75]
    v_mfma_f32_16x16x32_bf16 v[28:31], a[56:59], a[168:171], v[28:31]
    v_exp_f32 v18, v18
    v_mfma_f32_16x16x32_bf16 v[28:31], a[52:55], a[164:167], v[28:31]
    v_exp_f32 v19, v19
    v_mfma_f32_16x16x32_bf16 v[28:31], a[48:51], a[160:163], v[28:31]
    v_cvt_pk_bf16_f32 v49, v18, v19
    v_smfmac_f32_16x16x64_bf16 a[196:199], a[208:211], v[56:63], v101
    global_load_lds_dwordx4 v95, s[40:41] offset:3072
    v_mfma_f32_16x16x32_bf16 v[160:163], a[64:67], v[56:59], v[160:163]
    v_exp_f32 v20, v20
    v_mfma_f32_16x16x32_bf16 v[160:163], a[68:71], v[60:63], v[160:163]
    v_mfma_f32_16x16x32_bf16 v[164:167], a[76:79], v[60:63], v[164:167]
    v_exp_f32 v21, v21
    v_mfma_f32_16x16x32_bf16 v[164:167], a[72:75], v[56:59], v[164:167]
    v_cvt_pk_bf16_f32 v50, v20, v21
    v_mfma_f32_16x16x32_bf16 v[168:171], a[80:83], v[56:59], v[168:171]
    v_exp_f32 v22, v22
    v_mfma_f32_16x16x32_bf16 v[168:171], a[84:87], v[60:63], v[168:171]
    v_mfma_f32_16x16x32_bf16 v[172:175], a[92:95], v[60:63], v[172:175]
    v_exp_f32 v23, v23
    v_mfma_f32_16x16x32_bf16 v[172:175], a[88:91], v[56:59], v[172:175]
    v_cvt_pk_bf16_f32 v51, v22, v23
    v_mfma_f32_16x16x32_bf16 v[176:179], a[96:99], v[56:59], v[176:179]
    v_exp_f32 v24, v24
    v_mfma_f32_16x16x32_bf16 v[176:179], a[100:103], v[60:63], v[176:179]
    v_mfma_f32_16x16x32_bf16 v[180:183], a[108:111], v[60:63], v[180:183]
    v_exp_f32 v25, v25
    v_mfma_f32_16x16x32_bf16 v[180:183], a[104:107], v[56:59], v[180:183]
    v_cvt_pk_bf16_f32 v52, v24, v25
    v_mfma_f32_16x16x32_bf16 v[184:187], a[112:115], v[56:59], v[184:187]
    v_exp_f32 v26, v26
    v_mfma_f32_16x16x32_bf16 v[184:187], a[116:119], v[60:63], v[184:187]
    v_mfma_f32_16x16x32_bf16 v[188:191], a[124:127], v[60:63], v[188:191]
    v_exp_f32 v27, v27
    v_mfma_f32_16x16x32_bf16 v[188:191], a[120:123], v[56:59], v[188:191]
    v_cvt_pk_bf16_f32 v53, v26, v27
    v_mfma_f32_16x16x32_bf16 v[32:35], a[0:3], a[176:179], v[76:79]
    v_exp_f32 v28, v28
    v_mfma_f32_16x16x32_bf16 v[32:35], a[4:7], a[180:183], v[32:35]
    ds_read_b128 a[0:3], v80 offset:16384
    v_mfma_f32_16x16x32_bf16 v[32:35], a[8:11], a[184:187], v[32:35]
    v_exp_f32 v29, v29
    v_mfma_f32_16x16x32_bf16 v[32:35], a[12:15], a[188:191], v[32:35]
    ds_read_b128 a[4:7], v81 offset:16384
    v_cvt_pk_bf16_f32 v54, v28, v29
    v_mfma_f32_16x16x32_bf16 v[36:39], a[28:31], a[188:191], v[76:79]
    v_exp_f32 v30, v30
    v_mfma_f32_16x16x32_bf16 v[36:39], a[24:27], a[184:187], v[36:39]
    ds_read_b128 a[8:11], v82 offset:16384
    ds_read_b128 a[12:15], v83 offset:16384
    v_mfma_f32_16x16x32_bf16 v[36:39], a[20:23], a[180:183], v[36:39]
    v_exp_f32 v31, v31
    v_mfma_f32_16x16x32_bf16 v[36:39], a[16:19], a[176:179], v[36:39]
    ds_read_b128 a[28:31], v83 offset:20480
    v_cvt_pk_bf16_f32 v55, v30, v31
    v_mfma_f32_16x16x32_bf16 v[40:43], a[32:35], a[176:179], v[76:79]
    ds_read_b128 a[24:27], v82 offset:20480
    ds_read_b128 a[20:23], v81 offset:20480
    v_mfma_f32_16x16x32_bf16 v[40:43], a[36:39], a[180:183], v[40:43]
    v_exp_f32 v32, v32
    v_mfma_f32_16x16x32_bf16 v[40:43], a[40:43], a[184:187], v[40:43]
    ds_read_b128 a[16:19], v80 offset:20480
    ds_read_b128 a[32:35], v80 offset:24576
    v_mfma_f32_16x16x32_bf16 v[40:43], a[44:47], a[188:191], v[40:43]
    v_exp_f32 v33, v33
    v_mfma_f32_16x16x32_bf16 v[44:47], a[60:63], a[188:191], v[76:79]
    ds_read_b128 a[36:39], v81 offset:24576
    v_cvt_pk_bf16_f32 v56, v32, v33
    v_mfma_f32_16x16x32_bf16 v[44:47], a[56:59], a[184:187], v[44:47]
    v_exp_f32 v34, v34
    v_mfma_f32_16x16x32_bf16 v[44:47], a[52:55], a[180:183], v[44:47]
    ds_read_b128 a[40:43], v82 offset:24576
    ds_read_b128 a[44:47], v83 offset:24576
    v_mfma_f32_16x16x32_bf16 v[44:47], a[48:51], a[176:179], v[44:47]
    v_exp_f32 v35, v35
    v_smfmac_f32_16x16x64_bf16 a[200:203], a[208:211], v[48:55], v101
    ds_read_b128 a[60:63], v83 offset:28672
    ds_read_b128 a[56:59], v82 offset:28672
    v_mfma_f32_16x16x32_bf16 v[192:195], a[64:67], v[48:51], v[192:195]
    v_exp_f32 v36, v36
    v_mfma_f32_16x16x32_bf16 v[192:195], a[68:71], v[52:55], v[192:195]
    ds_read_b128 a[52:55], v81 offset:28672
    v_cvt_pk_bf16_f32 v57, v34, v35
    v_mfma_f32_16x16x32_bf16 v[196:199], a[76:79], v[52:55], v[196:199]
    v_exp_f32 v37, v37
    v_mfma_f32_16x16x32_bf16 v[196:199], a[72:75], v[48:51], v[196:199]
    ds_read_b128 a[48:51], v80 offset:28672
    v_cvt_pk_bf16_f32 v58, v36, v37
    v_mfma_f32_16x16x32_bf16 v[200:203], a[80:83], v[48:51], v[200:203]
    v_exp_f32 v38, v38
    v_mfma_f32_16x16x32_bf16 v[200:203], a[84:87], v[52:55], v[200:203]
    v_mfma_f32_16x16x32_bf16 v[204:207], a[92:95], v[52:55], v[204:207]
    v_exp_f32 v39, v39
    v_mfma_f32_16x16x32_bf16 v[204:207], a[88:91], v[48:51], v[204:207]
    v_cvt_pk_bf16_f32 v59, v38, v39
    v_mfma_f32_16x16x32_bf16 v[208:211], a[96:99], v[48:51], v[208:211]
    v_exp_f32 v40, v40
    v_mfma_f32_16x16x32_bf16 v[208:211], a[100:103], v[52:55], v[208:211]
    v_exp_f32 v41, v41
    v_mfma_f32_16x16x32_bf16 v[212:215], a[108:111], v[52:55], v[212:215]
    v_cvt_pk_bf16_f32 v60, v40, v41
    v_mfma_f32_16x16x32_bf16 v[212:215], a[104:107], v[48:51], v[212:215]
    v_exp_f32 v42, v42
    v_mfma_f32_16x16x32_bf16 v[216:219], a[112:115], v[48:51], v[216:219]
    s_waitcnt lgkmcnt(0)
    v_mfma_f32_16x16x32_bf16 v[216:219], a[116:119], v[52:55], v[216:219]
    v_exp_f32 v43, v43
    v_mfma_f32_16x16x32_bf16 v[220:223], a[124:127], v[52:55], v[220:223]
    v_cvt_pk_bf16_f32 v61, v42, v43
    v_mfma_f32_16x16x32_bf16 v[220:223], a[120:123], v[48:51], v[220:223]
    s_cbranch_scc1 L_last
    v_mfma_f32_16x16x32_bf16 v[16:19], a[0:3], a[128:131], v[64:67]
    v_exp_f32 v44, v44
    v_mfma_f32_16x16x32_bf16 v[16:19], a[4:7], a[132:135], v[16:19]
    s_add_u32 m0, s13, 0
    v_exp_f32 v45, v45
    v_mfma_f32_16x16x32_bf16 v[16:19], a[8:11], a[136:139], v[16:19]
    v_cvt_pk_bf16_f32 v62, v44, v45
    v_mfma_f32_16x16x32_bf16 v[16:19], a[12:15], a[140:143], v[16:19]
    global_load_lds_dwordx4 v96, s[42:43]
    v_mfma_f32_16x16x32_bf16 v[20:23], a[28:31], a[140:143], v[64:67]
    v_exp_f32 v46, v46
    v_mfma_f32_16x16x32_bf16 v[20:23], a[24:27], a[136:139], v[20:23]
    v_exp_f32 v47, v47
    v_mfma_f32_16x16x32_bf16 v[20:23], a[20:23], a[132:135], v[20:23]
    v_cvt_pk_bf16_f32 v63, v46, v47
    v_mfma_f32_16x16x32_bf16 v[20:23], a[16:19], a[128:131], v[20:23]
    global_load_lds_dwordx4 v97, s[42:43] offset:1024
    v_mfma_f32_16x16x32_bf16 v[24:27], a[32:35], a[128:131], v[64:67]
    v_exp_f32 v16, v16
    v_mfma_f32_16x16x32_bf16 v[24:27], a[36:39], a[132:135], v[24:27]
    v_exp_f32 v17, v17
    v_mfma_f32_16x16x32_bf16 v[24:27], a[40:43], a[136:139], v[24:27]
    v_cvt_pk_bf16_f32 v48, v16, v17
    v_mfma_f32_16x16x32_bf16 v[24:27], a[44:47], a[140:143], v[24:27]
    global_load_lds_dwordx4 v98, s[42:43] offset:2048
    v_mfma_f32_16x16x32_bf16 v[28:31], a[60:63], a[140:143], v[64:67]
    v_exp_f32 v18, v18
    v_mfma_f32_16x16x32_bf16 v[28:31], a[56:59], a[136:139], v[28:31]
    v_exp_f32 v19, v19
    v_mfma_f32_16x16x32_bf16 v[28:31], a[52:55], a[132:135], v[28:31]
    v_exp_f32 v20, v20
    v_mfma_f32_16x16x32_bf16 v[28:31], a[48:51], a[128:131], v[28:31]
    v_cvt_pk_bf16_f32 v49, v18, v19
    v_smfmac_f32_16x16x64_bf16 a[204:207], a[208:211], v[56:63], v101
    global_load_lds_dwordx4 v99, s[42:43] offset:3072
    v_mfma_f32_16x16x32_bf16 v[224:227], a[64:67], v[56:59], v[224:227]
    v_exp_f32 v21, v21
    v_mfma_f32_16x16x32_bf16 v[224:227], a[68:71], v[60:63], v[224:227]
    ds_read_b64_tr_b16 a[64:65], v84 offset:16384
    v_cvt_pk_bf16_f32 v50, v20, v21
    v_mfma_f32_16x16x32_bf16 v[228:231], a[76:79], v[60:63], v[228:231]
    ds_read_b64_tr_b16 a[66:67], v84 offset:20480
    ds_read_b64_tr_b16 a[68:69], v84 offset:24576
    v_mfma_f32_16x16x32_bf16 v[228:231], a[72:75], v[56:59], v[228:231]
    v_exp_f32 v22, v22
    v_mfma_f32_16x16x32_bf16 v[232:235], a[80:83], v[56:59], v[232:235]
    ds_read_b64_tr_b16 a[70:71], v84 offset:28672
    ds_read_b64_tr_b16 a[76:77], v85 offset:24576
    v_mfma_f32_16x16x32_bf16 v[232:235], a[84:87], v[60:63], v[232:235]
    v_exp_f32 v23, v23
    v_mfma_f32_16x16x32_bf16 v[236:239], a[92:95], v[60:63], v[236:239]
    ds_read_b64_tr_b16 a[78:79], v85 offset:28672
    v_cvt_pk_bf16_f32 v51, v22, v23
    v_mfma_f32_16x16x32_bf16 v[236:239], a[88:91], v[56:59], v[236:239]
    ds_read_b64_tr_b16 a[72:73], v85 offset:16384
    ds_read_b64_tr_b16 a[74:75], v85 offset:20480
    v_mfma_f32_16x16x32_bf16 v[240:243], a[96:99], v[56:59], v[240:243]
    v_exp_f32 v24, v24
    v_mfma_f32_16x16x32_bf16 v[240:243], a[100:103], v[60:63], v[240:243]
    ds_read_b64_tr_b16 a[80:81], v86 offset:16384
    ds_read_b64_tr_b16 a[82:83], v86 offset:20480
    v_mfma_f32_16x16x32_bf16 v[244:247], a[108:111], v[60:63], v[244:247]
    v_exp_f32 v25, v25
    v_mfma_f32_16x16x32_bf16 v[244:247], a[104:107], v[56:59], v[244:247]
    ds_read_b64_tr_b16 a[84:85], v86 offset:24576
    v_cvt_pk_bf16_f32 v52, v24, v25
    v_mfma_f32_16x16x32_bf16 v[248:251], a[112:115], v[56:59], v[248:251]
    ds_read_b64_tr_b16 a[86:87], v86 offset:28672
    ds_read_b64_tr_b16 a[92:93], v87 offset:24576
    v_mfma_f32_16x16x32_bf16 v[248:251], a[116:119], v[60:63], v[248:251]
    v_exp_f32 v26, v26
    v_mfma_f32_16x16x32_bf16 v[252:255], a[124:127], v[60:63], v[252:255]
    ds_read_b64_tr_b16 a[94:95], v87 offset:28672
    ds_read_b64_tr_b16 a[88:89], v87 offset:16384
    v_mfma_f32_16x16x32_bf16 v[252:255], a[120:123], v[56:59], v[252:255]
    v_exp_f32 v27, v27
    v_mfma_f32_16x16x32_bf16 v[32:35], a[0:3], a[144:147], v[68:71]
    ds_read_b64_tr_b16 a[90:91], v87 offset:20480
    v_cvt_pk_bf16_f32 v53, v26, v27
    v_mfma_f32_16x16x32_bf16 v[32:35], a[4:7], a[148:151], v[32:35]
    ds_read_b64_tr_b16 a[96:97], v88 offset:16384
    ds_read_b64_tr_b16 a[98:99], v88 offset:20480
    v_mfma_f32_16x16x32_bf16 v[32:35], a[8:11], a[152:155], v[32:35]
    v_exp_f32 v28, v28
    v_mfma_f32_16x16x32_bf16 v[32:35], a[12:15], a[156:159], v[32:35]
    ds_read_b64_tr_b16 a[100:101], v88 offset:24576
    ds_read_b64_tr_b16 a[102:103], v88 offset:28672
    v_mfma_f32_16x16x32_bf16 v[36:39], a[28:31], a[156:159], v[68:71]
    v_exp_f32 v29, v29
    v_mfma_f32_16x16x32_bf16 v[36:39], a[24:27], a[152:155], v[36:39]
    ds_read_b64_tr_b16 a[108:109], v89 offset:24576
    v_cvt_pk_bf16_f32 v54, v28, v29
    v_mfma_f32_16x16x32_bf16 v[36:39], a[20:23], a[148:151], v[36:39]
    ds_read_b64_tr_b16 a[110:111], v89 offset:28672
    ds_read_b64_tr_b16 a[104:105], v89 offset:16384
    v_mfma_f32_16x16x32_bf16 v[36:39], a[16:19], a[144:147], v[36:39]
    v_exp_f32 v30, v30
    v_mfma_f32_16x16x32_bf16 v[40:43], a[32:35], a[144:147], v[68:71]
    ds_read_b64_tr_b16 a[106:107], v89 offset:20480
    ds_read_b64_tr_b16 a[112:113], v90 offset:16384
    v_mfma_f32_16x16x32_bf16 v[40:43], a[36:39], a[148:151], v[40:43]
    v_exp_f32 v31, v31
    v_mfma_f32_16x16x32_bf16 v[40:43], a[40:43], a[152:155], v[40:43]
    ds_read_b64_tr_b16 a[114:115], v90 offset:20480
    v_cvt_pk_bf16_f32 v55, v30, v31
    v_mfma_f32_16x16x32_bf16 v[40:43], a[44:47], a[156:159], v[40:43]
    ds_read_b64_tr_b16 a[116:117], v90 offset:24576
    ds_read_b64_tr_b16 a[118:119], v90 offset:28672
    v_mfma_f32_16x16x32_bf16 v[44:47], a[60:63], a[156:159], v[68:71]
    v_exp_f32 v32, v32
    v_mfma_f32_16x16x32_bf16 v[44:47], a[56:59], a[152:155], v[44:47]
    ds_read_b64_tr_b16 a[124:125], v91 offset:24576
    ds_read_b64_tr_b16 a[126:127], v91 offset:28672
    v_mfma_f32_16x16x32_bf16 v[44:47], a[52:55], a[148:151], v[44:47]
    v_exp_f32 v33, v33
    v_mfma_f32_16x16x32_bf16 v[44:47], a[48:51], a[144:147], v[44:47]
    ds_read_b64_tr_b16 a[120:121], v91 offset:16384
    v_cvt_pk_bf16_f32 v56, v32, v33
    v_smfmac_f32_16x16x64_bf16 a[192:195], a[208:211], v[48:55], v101
    s_waitcnt lgkmcnt(7)
    ds_read_b64_tr_b16 a[122:123], v91 offset:20480
    v_mfma_f32_16x16x32_bf16 v[128:131], a[64:67], v[48:51], v[128:131]
    v_exp_f32 v34, v34
    v_mfma_f32_16x16x32_bf16 v[128:131], a[68:71], v[52:55], v[128:131]
    v_exp_f32 v35, v35
    v_mfma_f32_16x16x32_bf16 v[132:135], a[76:79], v[52:55], v[132:135]
    v_cvt_pk_bf16_f32 v57, v34, v35
    v_readlane_b32 s10, v100, s8
    v_mfma_f32_16x16x32_bf16 v[132:135], a[72:75], v[48:51], v[132:135]
    v_exp_f32 v36, v36
    v_mfma_f32_16x16x32_bf16 v[136:139], a[80:83], v[48:51], v[136:139]
    v_exp_f32 v37, v37
    v_mfma_f32_16x16x32_bf16 v[136:139], a[84:87], v[52:55], v[136:139]
    s_add_u32 s40, s18, s10
    v_cvt_pk_bf16_f32 v58, v36, v37
    v_mfma_f32_16x16x32_bf16 v[140:143], a[92:95], v[52:55], v[140:143]
    s_addc_u32 s41, s19, 0
    v_exp_f32 v38, v38
    v_mfma_f32_16x16x32_bf16 v[140:143], a[88:91], v[48:51], v[140:143]
    s_waitcnt vmcnt(8) lgkmcnt(0)
    v_exp_f32 v39, v39
    v_mfma_f32_16x16x32_bf16 v[144:147], a[96:99], v[48:51], v[144:147]
    s_barrier
    v_mfma_f32_16x16x32_bf16 v[144:147], a[100:103], v[52:55], v[144:147]
    s_add_u32 m0, s12, 16384
    v_cvt_pk_bf16_f32 v59, v38, v39
    v_mfma_f32_16x16x32_bf16 v[148:151], a[108:111], v[52:55], v[148:151]
    global_load_lds_dwordx4 v92, s[40:41]
    v_mfma_f32_16x16x32_bf16 v[148:151], a[104:107], v[48:51], v[148:151]
    s_add_u32 s42, s20, s10
    v_exp_f32 v40, v40
    v_mfma_f32_16x16x32_bf16 v[152:155], a[112:115], v[48:51], v[152:155]
    s_addc_u32 s43, s21, 0
    v_exp_f32 v41, v41
    v_mfma_f32_16x16x32_bf16 v[152:155], a[116:119], v[52:55], v[152:155]
    s_add_u32 s8, s8, 1
    v_cvt_pk_bf16_f32 v60, v40, v41
    v_mfma_f32_16x16x32_bf16 v[156:159], a[124:127], v[52:55], v[156:159]
    s_cmp_eq_u32 s8, s9
    v_exp_f32 v42, v42
    v_mfma_f32_16x16x32_bf16 v[156:159], a[120:123], v[48:51], v[156:159]
    v_exp_f32 v43, v43
    v_mfma_f32_16x16x32_bf16 v[16:19], a[0:3], a[160:163], v[72:75]
    s_mov_b32 s33, 32768
    v_cvt_pk_bf16_f32 v61, v42, v43
    v_mfma_f32_16x16x32_bf16 v[16:19], a[4:7], a[164:167], v[16:19]
    global_load_lds_dwordx4 v93, s[40:41] offset:1024
    v_mfma_f32_16x16x32_bf16 v[16:19], a[8:11], a[168:171], v[16:19]
    v_exp_f32 v44, v44
    v_mfma_f32_16x16x32_bf16 v[16:19], a[12:15], a[172:175], v[16:19]
    v_exp_f32 v45, v45
    v_mfma_f32_16x16x32_bf16 v[20:23], a[28:31], a[172:175], v[72:75]
    v_cvt_pk_bf16_f32 v62, v44, v45
    v_mfma_f32_16x16x32_bf16 v[20:23], a[24:27], a[168:171], v[20:23]
    v_exp_f32 v46, v46
    v_mfma_f32_16x16x32_bf16 v[20:23], a[20:23], a[164:167], v[20:23]
    v_exp_f32 v47, v47
    v_mfma_f32_16x16x32_bf16 v[20:23], a[16:19], a[160:163], v[20:23]
    v_cvt_pk_bf16_f32 v63, v46, v47
    v_mfma_f32_16x16x32_bf16 v[24:27], a[32:35], a[160:163], v[72:75]
    global_load_lds_dwordx4 v94, s[40:41] offset:2048
    v_mfma_f32_16x16x32_bf16 v[24:27], a[36:39], a[164:167], v[24:27]
    v_exp_f32 v16, v16
    v_mfma_f32_16x16x32_bf16 v[24:27], a[40:43], a[168:171], v[24:27]
    v_exp_f32 v17, v17
    v_mfma_f32_16x16x32_bf16 v[24:27], a[44:47], a[172:175], v[24:27]
    v_cvt_pk_bf16_f32 v48, v16, v17
    v_mfma_f32_16x16x32_bf16 v[28:31], a[60:63], a[172:175], v[72:75]
    v_mfma_f32_16x16x32_bf16 v[28:31], a[56:59], a[168:171], v[28:31]
    v_exp_f32 v18, v18
    v_mfma_f32_16x16x32_bf16 v[28:31], a[52:55], a[164:167], v[28:31]
    v_exp_f32 v19, v19
    v_mfma_f32_16x16x32_bf16 v[28:31], a[48:51], a[160:163], v[28:31]
    v_cvt_pk_bf16_f32 v49, v18, v19
    v_smfmac_f32_16x16x64_bf16 a[196:199], a[208:211], v[56:63], v101
    global_load_lds_dwordx4 v95, s[40:41] offset:3072
    v_mfma_f32_16x16x32_bf16 v[160:163], a[64:67], v[56:59], v[160:163]
    v_exp_f32 v20, v20
    v_mfma_f32_16x16x32_bf16 v[160:163], a[68:71], v[60:63], v[160:163]
    v_mfma_f32_16x16x32_bf16 v[164:167], a[76:79], v[60:63], v[164:167]
    v_exp_f32 v21, v21
    v_mfma_f32_16x16x32_bf16 v[164:167], a[72:75], v[56:59], v[164:167]
    v_cvt_pk_bf16_f32 v50, v20, v21
    v_mfma_f32_16x16x32_bf16 v[168:171], a[80:83], v[56:59], v[168:171]
    v_exp_f32 v22, v22
    v_mfma_f32_16x16x32_bf16 v[168:171], a[84:87], v[60:63], v[168:171]
    v_mfma_f32_16x16x32_bf16 v[172:175], a[92:95], v[60:63], v[172:175]
    v_exp_f32 v23, v23
    v_mfma_f32_16x16x32_bf16 v[172:175], a[88:91], v[56:59], v[172:175]
    v_cvt_pk_bf16_f32 v51, v22, v23
    v_mfma_f32_16x16x32_bf16 v[176:179], a[96:99], v[56:59], v[176:179]
    v_exp_f32 v24, v24
    v_mfma_f32_16x16x32_bf16 v[176:179], a[100:103], v[60:63], v[176:179]
    v_mfma_f32_16x16x32_bf16 v[180:183], a[108:111], v[60:63], v[180:183]
    v_exp_f32 v25, v25
    v_mfma_f32_16x16x32_bf16 v[180:183], a[104:107], v[56:59], v[180:183]
    v_cvt_pk_bf16_f32 v52, v24, v25
    v_mfma_f32_16x16x32_bf16 v[184:187], a[112:115], v[56:59], v[184:187]
    v_exp_f32 v26, v26
    v_mfma_f32_16x16x32_bf16 v[184:187], a[116:119], v[60:63], v[184:187]
    v_mfma_f32_16x16x32_bf16 v[188:191], a[124:127], v[60:63], v[188:191]
    v_exp_f32 v27, v27
    v_mfma_f32_16x16x32_bf16 v[188:191], a[120:123], v[56:59], v[188:191]
    v_cvt_pk_bf16_f32 v53, v26, v27
    v_mfma_f32_16x16x32_bf16 v[32:35], a[0:3], a[176:179], v[76:79]
    v_exp_f32 v28, v28
    v_mfma_f32_16x16x32_bf16 v[32:35], a[4:7], a[180:183], v[32:35]
    ds_read_b128 a[0:3], v80 offset:32768
    v_mfma_f32_16x16x32_bf16 v[32:35], a[8:11], a[184:187], v[32:35]
    v_exp_f32 v29, v29
    v_mfma_f32_16x16x32_bf16 v[32:35], a[12:15], a[188:191], v[32:35]
    ds_read_b128 a[4:7], v81 offset:32768
    v_cvt_pk_bf16_f32 v54, v28, v29
    v_mfma_f32_16x16x32_bf16 v[36:39], a[28:31], a[188:191], v[76:79]
    v_exp_f32 v30, v30
    v_mfma_f32_16x16x32_bf16 v[36:39], a[24:27], a[184:187], v[36:39]
    ds_read_b128 a[8:11], v82 offset:32768
    ds_read_b128 a[12:15], v83 offset:32768
    v_mfma_f32_16x16x32_bf16 v[36:39], a[20:23], a[180:183], v[36:39]
    v_exp_f32 v31, v31
    v_mfma_f32_16x16x32_bf16 v[36:39], a[16:19], a[176:179], v[36:39]
    ds_read_b128 a[28:31], v83 offset:36864
    v_cvt_pk_bf16_f32 v55, v30, v31
    v_mfma_f32_16x16x32_bf16 v[40:43], a[32:35], a[176:179], v[76:79]
    ds_read_b128 a[24:27], v82 offset:36864
    ds_read_b128 a[20:23], v81 offset:36864
    v_mfma_f32_16x16x32_bf16 v[40:43], a[36:39], a[180:183], v[40:43]
    v_exp_f32 v32, v32
    v_mfma_f32_16x16x32_bf16 v[40:43], a[40:43], a[184:187], v[40:43]
    ds_read_b128 a[16:19], v80 offset:36864
    ds_read_b128 a[32:35], v80 offset:40960
    v_mfma_f32_16x16x32_bf16 v[40:43], a[44:47], a[188:191], v[40:43]
    v_exp_f32 v33, v33
    v_mfma_f32_16x16x32_bf16 v[44:47], a[60:63], a[188:191], v[76:79]
    ds_read_b128 a[36:39], v81 offset:40960
    v_cvt_pk_bf16_f32 v56, v32, v33
    v_mfma_f32_16x16x32_bf16 v[44:47], a[56:59], a[184:187], v[44:47]
    v_exp_f32 v34, v34
    v_mfma_f32_16x16x32_bf16 v[44:47], a[52:55], a[180:183], v[44:47]
    ds_read_b128 a[40:43], v82 offset:40960
    ds_read_b128 a[44:47], v83 offset:40960
    v_mfma_f32_16x16x32_bf16 v[44:47], a[48:51], a[176:179], v[44:47]
    v_exp_f32 v35, v35
    v_smfmac_f32_16x16x64_bf16 a[200:203], a[208:211], v[48:55], v101
    ds_read_b128 a[60:63], v83 offset:45056
    ds_read_b128 a[56:59], v82 offset:45056
    v_mfma_f32_16x16x32_bf16 v[192:195], a[64:67], v[48:51], v[192:195]
    v_exp_f32 v36, v36
    v_mfma_f32_16x16x32_bf16 v[192:195], a[68:71], v[52:55], v[192:195]
    ds_read_b128 a[52:55], v81 offset:45056
    v_cvt_pk_bf16_f32 v57, v34, v35
    v_mfma_f32_16x16x32_bf16 v[196:199], a[76:79], v[52:55], v[196:199]
    v_exp_f32 v37, v37
    v_mfma_f32_16x16x32_bf16 v[196:199], a[72:75], v[48:51], v[196:199]
    ds_read_b128 a[48:51], v80 offset:45056
    v_cvt_pk_bf16_f32 v58, v36, v37
    v_mfma_f32_16x16x32_bf16 v[200:203], a[80:83], v[48:51], v[200:203]
    v_exp_f32 v38, v38
    v_mfma_f32_16x16x32_bf16 v[200:203], a[84:87], v[52:55], v[200:203]
    v_mfma_f32_16x16x32_bf16 v[204:207], a[92:95], v[52:55], v[204:207]
    v_exp_f32 v39, v39
    v_mfma_f32_16x16x32_bf16 v[204:207], a[88:91], v[48:51], v[204:207]
    v_cvt_pk_bf16_f32 v59, v38, v39
    v_mfma_f32_16x16x32_bf16 v[208:211], a[96:99], v[48:51], v[208:211]
    v_exp_f32 v40, v40
    v_mfma_f32_16x16x32_bf16 v[208:211], a[100:103], v[52:55], v[208:211]
    v_exp_f32 v41, v41
    v_mfma_f32_16x16x32_bf16 v[212:215], a[108:111], v[52:55], v[212:215]
    v_cvt_pk_bf16_f32 v60, v40, v41
    v_mfma_f32_16x16x32_bf16 v[212:215], a[104:107], v[48:51], v[212:215]
    v_exp_f32 v42, v42
    v_mfma_f32_16x16x32_bf16 v[216:219], a[112:115], v[48:51], v[216:219]
    s_waitcnt lgkmcnt(0)
    v_mfma_f32_16x16x32_bf16 v[216:219], a[116:119], v[52:55], v[216:219]
    v_exp_f32 v43, v43
    v_mfma_f32_16x16x32_bf16 v[220:223], a[124:127], v[52:55], v[220:223]
    v_cvt_pk_bf16_f32 v61, v42, v43
    v_mfma_f32_16x16x32_bf16 v[220:223], a[120:123], v[48:51], v[220:223]
    s_cbranch_scc1 L_last
    v_mfma_f32_16x16x32_bf16 v[16:19], a[0:3], a[128:131], v[64:67]
    v_exp_f32 v44, v44
    v_mfma_f32_16x16x32_bf16 v[16:19], a[4:7], a[132:135], v[16:19]
    s_add_u32 m0, s13, 16384
    v_exp_f32 v45, v45
    v_mfma_f32_16x16x32_bf16 v[16:19], a[8:11], a[136:139], v[16:19]
    v_cvt_pk_bf16_f32 v62, v44, v45
    v_mfma_f32_16x16x32_bf16 v[16:19], a[12:15], a[140:143], v[16:19]
    global_load_lds_dwordx4 v96, s[42:43]
    v_mfma_f32_16x16x32_bf16 v[20:23], a[28:31], a[140:143], v[64:67]
    v_exp_f32 v46, v46
    v_mfma_f32_16x16x32_bf16 v[20:23], a[24:27], a[136:139], v[20:23]
    v_exp_f32 v47, v47
    v_mfma_f32_16x16x32_bf16 v[20:23], a[20:23], a[132:135], v[20:23]
    v_cvt_pk_bf16_f32 v63, v46, v47
    v_mfma_f32_16x16x32_bf16 v[20:23], a[16:19], a[128:131], v[20:23]
    global_load_lds_dwordx4 v97, s[42:43] offset:1024
    v_mfma_f32_16x16x32_bf16 v[24:27], a[32:35], a[128:131], v[64:67]
    v_exp_f32 v16, v16
    v_mfma_f32_16x16x32_bf16 v[24:27], a[36:39], a[132:135], v[24:27]
    v_exp_f32 v17, v17
    v_mfma_f32_16x16x32_bf16 v[24:27], a[40:43], a[136:139], v[24:27]
    v_cvt_pk_bf16_f32 v48, v16, v17
    v_mfma_f32_16x16x32_bf16 v[24:27], a[44:47], a[140:143], v[24:27]
    global_load_lds_dwordx4 v98, s[42:43] offset:2048
    v_mfma_f32_16x16x32_bf16 v[28:31], a[60:63], a[140:143], v[64:67]
    v_exp_f32 v18, v18
    v_mfma_f32_16x16x32_bf16 v[28:31], a[56:59], a[136:139], v[28:31]
    v_exp_f32 v19, v19
    v_mfma_f32_16x16x32_bf16 v[28:31], a[52:55], a[132:135], v[28:31]
    v_exp_f32 v20, v20
    v_mfma_f32_16x16x32_bf16 v[28:31], a[48:51], a[128:131], v[28:31]
    v_cvt_pk_bf16_f32 v49, v18, v19
    v_smfmac_f32_16x16x64_bf16 a[204:207], a[208:211], v[56:63], v101
    global_load_lds_dwordx4 v99, s[42:43] offset:3072
    v_mfma_f32_16x16x32_bf16 v[224:227], a[64:67], v[56:59], v[224:227]
    v_exp_f32 v21, v21
    v_mfma_f32_16x16x32_bf16 v[224:227], a[68:71], v[60:63], v[224:227]
    ds_read_b64_tr_b16 a[64:65], v84 offset:32768
    v_cvt_pk_bf16_f32 v50, v20, v21
    v_mfma_f32_16x16x32_bf16 v[228:231], a[76:79], v[60:63], v[228:231]
    ds_read_b64_tr_b16 a[66:67], v84 offset:36864
    ds_read_b64_tr_b16 a[68:69], v84 offset:40960
    v_mfma_f32_16x16x32_bf16 v[228:231], a[72:75], v[56:59], v[228:231]
    v_exp_f32 v22, v22
    v_mfma_f32_16x16x32_bf16 v[232:235], a[80:83], v[56:59], v[232:235]
    ds_read_b64_tr_b16 a[70:71], v84 offset:45056
    ds_read_b64_tr_b16 a[76:77], v85 offset:40960
    v_mfma_f32_16x16x32_bf16 v[232:235], a[84:87], v[60:63], v[232:235]
    v_exp_f32 v23, v23
    v_mfma_f32_16x16x32_bf16 v[236:239], a[92:95], v[60:63], v[236:239]
    ds_read_b64_tr_b16 a[78:79], v85 offset:45056
    v_cvt_pk_bf16_f32 v51, v22, v23
    v_mfma_f32_16x16x32_bf16 v[236:239], a[88:91], v[56:59], v[236:239]
    ds_read_b64_tr_b16 a[72:73], v85 offset:32768
    ds_read_b64_tr_b16 a[74:75], v85 offset:36864
    v_mfma_f32_16x16x32_bf16 v[240:243], a[96:99], v[56:59], v[240:243]
    v_exp_f32 v24, v24
    v_mfma_f32_16x16x32_bf16 v[240:243], a[100:103], v[60:63], v[240:243]
    ds_read_b64_tr_b16 a[80:81], v86 offset:32768
    ds_read_b64_tr_b16 a[82:83], v86 offset:36864
    v_mfma_f32_16x16x32_bf16 v[244:247], a[108:111], v[60:63], v[244:247]
    v_exp_f32 v25, v25
    v_mfma_f32_16x16x32_bf16 v[244:247], a[104:107], v[56:59], v[244:247]
    ds_read_b64_tr_b16 a[84:85], v86 offset:40960
    v_cvt_pk_bf16_f32 v52, v24, v25
    v_mfma_f32_16x16x32_bf16 v[248:251], a[112:115], v[56:59], v[248:251]
    ds_read_b64_tr_b16 a[86:87], v86 offset:45056
    ds_read_b64_tr_b16 a[92:93], v87 offset:40960
    v_mfma_f32_16x16x32_bf16 v[248:251], a[116:119], v[60:63], v[248:251]
    v_exp_f32 v26, v26
    v_mfma_f32_16x16x32_bf16 v[252:255], a[124:127], v[60:63], v[252:255]
    ds_read_b64_tr_b16 a[94:95], v87 offset:45056
    ds_read_b64_tr_b16 a[88:89], v87 offset:32768
    v_mfma_f32_16x16x32_bf16 v[252:255], a[120:123], v[56:59], v[252:255]
    v_exp_f32 v27, v27
    v_mfma_f32_16x16x32_bf16 v[32:35], a[0:3], a[144:147], v[68:71]
    ds_read_b64_tr_b16 a[90:91], v87 offset:36864
    v_cvt_pk_bf16_f32 v53, v26, v27
    v_mfma_f32_16x16x32_bf16 v[32:35], a[4:7], a[148:151], v[32:35]
    ds_read_b64_tr_b16 a[96:97], v88 offset:32768
    ds_read_b64_tr_b16 a[98:99], v88 offset:36864
    v_mfma_f32_16x16x32_bf16 v[32:35], a[8:11], a[152:155], v[32:35]
    v_exp_f32 v28, v28
    v_mfma_f32_16x16x32_bf16 v[32:35], a[12:15], a[156:159], v[32:35]
    ds_read_b64_tr_b16 a[100:101], v88 offset:40960
    ds_read_b64_tr_b16 a[102:103], v88 offset:45056
    v_mfma_f32_16x16x32_bf16 v[36:39], a[28:31], a[156:159], v[68:71]
    v_exp_f32 v29, v29
    v_mfma_f32_16x16x32_bf16 v[36:39], a[24:27], a[152:155], v[36:39]
    ds_read_b64_tr_b16 a[108:109], v89 offset:40960
    v_cvt_pk_bf16_f32 v54, v28, v29
    v_mfma_f32_16x16x32_bf16 v[36:39], a[20:23], a[148:151], v[36:39]
    ds_read_b64_tr_b16 a[110:111], v89 offset:45056
    ds_read_b64_tr_b16 a[104:105], v89 offset:32768
    v_mfma_f32_16x16x32_bf16 v[36:39], a[16:19], a[144:147], v[36:39]
    v_exp_f32 v30, v30
    v_mfma_f32_16x16x32_bf16 v[40:43], a[32:35], a[144:147], v[68:71]
    ds_read_b64_tr_b16 a[106:107], v89 offset:36864
    ds_read_b64_tr_b16 a[112:113], v90 offset:32768
    v_mfma_f32_16x16x32_bf16 v[40:43], a[36:39], a[148:151], v[40:43]
    v_exp_f32 v31, v31
    v_mfma_f32_16x16x32_bf16 v[40:43], a[40:43], a[152:155], v[40:43]
    ds_read_b64_tr_b16 a[114:115], v90 offset:36864
    v_cvt_pk_bf16_f32 v55, v30, v31
    v_mfma_f32_16x16x32_bf16 v[40:43], a[44:47], a[156:159], v[40:43]
    ds_read_b64_tr_b16 a[116:117], v90 offset:40960
    ds_read_b64_tr_b16 a[118:119], v90 offset:45056
    v_mfma_f32_16x16x32_bf16 v[44:47], a[60:63], a[156:159], v[68:71]
    v_exp_f32 v32, v32
    v_mfma_f32_16x16x32_bf16 v[44:47], a[56:59], a[152:155], v[44:47]
    ds_read_b64_tr_b16 a[124:125], v91 offset:40960
    ds_read_b64_tr_b16 a[126:127], v91 offset:45056
    v_mfma_f32_16x16x32_bf16 v[44:47], a[52:55], a[148:151], v[44:47]
    v_exp_f32 v33, v33
    v_mfma_f32_16x16x32_bf16 v[44:47], a[48:51], a[144:147], v[44:47]
    ds_read_b64_tr_b16 a[120:121], v91 offset:32768
    v_cvt_pk_bf16_f32 v56, v32, v33
    v_smfmac_f32_16x16x64_bf16 a[192:195], a[208:211], v[48:55], v101
    s_waitcnt lgkmcnt(7)
    ds_read_b64_tr_b16 a[122:123], v91 offset:36864
    v_mfma_f32_16x16x32_bf16 v[128:131], a[64:67], v[48:51], v[128:131]
    v_exp_f32 v34, v34
    v_mfma_f32_16x16x32_bf16 v[128:131], a[68:71], v[52:55], v[128:131]
    v_exp_f32 v35, v35
    v_mfma_f32_16x16x32_bf16 v[132:135], a[76:79], v[52:55], v[132:135]
    v_cvt_pk_bf16_f32 v57, v34, v35
    v_readlane_b32 s10, v100, s8
    v_mfma_f32_16x16x32_bf16 v[132:135], a[72:75], v[48:51], v[132:135]
    v_exp_f32 v36, v36
    v_mfma_f32_16x16x32_bf16 v[136:139], a[80:83], v[48:51], v[136:139]
    v_exp_f32 v37, v37
    v_mfma_f32_16x16x32_bf16 v[136:139], a[84:87], v[52:55], v[136:139]
    s_add_u32 s40, s18, s10
    v_cvt_pk_bf16_f32 v58, v36, v37
    v_mfma_f32_16x16x32_bf16 v[140:143], a[92:95], v[52:55], v[140:143]
    s_addc_u32 s41, s19, 0
    v_exp_f32 v38, v38
    v_mfma_f32_16x16x32_bf16 v[140:143], a[88:91], v[48:51], v[140:143]
    s_waitcnt vmcnt(8) lgkmcnt(0)
    v_exp_f32 v39, v39
    v_mfma_f32_16x16x32_bf16 v[144:147], a[96:99], v[48:51], v[144:147]
    s_barrier
    v_mfma_f32_16x16x32_bf16 v[144:147], a[100:103], v[52:55], v[144:147]
    s_add_u32 m0, s12, 32768
    v_cvt_pk_bf16_f32 v59, v38, v39
    v_mfma_f32_16x16x32_bf16 v[148:151], a[108:111], v[52:55], v[148:151]
    global_load_lds_dwordx4 v92, s[40:41]
    v_mfma_f32_16x16x32_bf16 v[148:151], a[104:107], v[48:51], v[148:151]
    s_add_u32 s42, s20, s10
    v_exp_f32 v40, v40
    v_mfma_f32_16x16x32_bf16 v[152:155], a[112:115], v[48:51], v[152:155]
    s_addc_u32 s43, s21, 0
    v_exp_f32 v41, v41
    v_mfma_f32_16x16x32_bf16 v[152:155], a[116:119], v[52:55], v[152:155]
    s_add_u32 s8, s8, 1
    v_cvt_pk_bf16_f32 v60, v40, v41
    v_mfma_f32_16x16x32_bf16 v[156:159], a[124:127], v[52:55], v[156:159]
    s_cmp_eq_u32 s8, s9
    v_exp_f32 v42, v42
    v_mfma_f32_16x16x32_bf16 v[156:159], a[120:123], v[48:51], v[156:159]
    v_exp_f32 v43, v43
    v_mfma_f32_16x16x32_bf16 v[16:19], a[0:3], a[160:163], v[72:75]
    s_mov_b32 s33, 0
    v_cvt_pk_bf16_f32 v61, v42, v43
    v_mfma_f32_16x16x32_bf16 v[16:19], a[4:7], a[164:167], v[16:19]
    global_load_lds_dwordx4 v93, s[40:41] offset:1024
    v_mfma_f32_16x16x32_bf16 v[16:19], a[8:11], a[168:171], v[16:19]
    v_exp_f32 v44, v44
    v_mfma_f32_16x16x32_bf16 v[16:19], a[12:15], a[172:175], v[16:19]
    v_exp_f32 v45, v45
    v_mfma_f32_16x16x32_bf16 v[20:23], a[28:31], a[172:175], v[72:75]
    v_cvt_pk_bf16_f32 v62, v44, v45
    v_mfma_f32_16x16x32_bf16 v[20:23], a[24:27], a[168:171], v[20:23]
    v_exp_f32 v46, v46
    v_mfma_f32_16x16x32_bf16 v[20:23], a[20:23], a[164:167], v[20:23]
    v_exp_f32 v47, v47
    v_mfma_f32_16x16x32_bf16 v[20:23], a[16:19], a[160:163], v[20:23]
    v_cvt_pk_bf16_f32 v63, v46, v47
    v_mfma_f32_16x16x32_bf16 v[24:27], a[32:35], a[160:163], v[72:75]
    global_load_lds_dwordx4 v94, s[40:41] offset:2048
    v_mfma_f32_16x16x32_bf16 v[24:27], a[36:39], a[164:167], v[24:27]
    v_exp_f32 v16, v16
    v_mfma_f32_16x16x32_bf16 v[24:27], a[40:43], a[168:171], v[24:27]
    v_exp_f32 v17, v17
    v_mfma_f32_16x16x32_bf16 v[24:27], a[44:47], a[172:175], v[24:27]
    v_cvt_pk_bf16_f32 v48, v16, v17
    v_mfma_f32_16x16x32_bf16 v[28:31], a[60:63], a[172:175], v[72:75]
    v_mfma_f32_16x16x32_bf16 v[28:31], a[56:59], a[168:171], v[28:31]
    v_exp_f32 v18, v18
    v_mfma_f32_16x16x32_bf16 v[28:31], a[52:55], a[164:167], v[28:31]
    v_exp_f32 v19, v19
    v_mfma_f32_16x16x32_bf16 v[28:31], a[48:51], a[160:163], v[28:31]
    v_cvt_pk_bf16_f32 v49, v18, v19
    v_smfmac_f32_16x16x64_bf16 a[196:199], a[208:211], v[56:63], v101
    global_load_lds_dwordx4 v95, s[40:41] offset:3072
    v_mfma_f32_16x16x32_bf16 v[160:163], a[64:67], v[56:59], v[160:163]
    v_exp_f32 v20, v20
    v_mfma_f32_16x16x32_bf16 v[160:163], a[68:71], v[60:63], v[160:163]
    v_mfma_f32_16x16x32_bf16 v[164:167], a[76:79], v[60:63], v[164:167]
    v_exp_f32 v21, v21
    v_mfma_f32_16x16x32_bf16 v[164:167], a[72:75], v[56:59], v[164:167]
    v_cvt_pk_bf16_f32 v50, v20, v21
    v_mfma_f32_16x16x32_bf16 v[168:171], a[80:83], v[56:59], v[168:171]
    v_exp_f32 v22, v22
    v_mfma_f32_16x16x32_bf16 v[168:171], a[84:87], v[60:63], v[168:171]
    v_mfma_f32_16x16x32_bf16 v[172:175], a[92:95], v[60:63], v[172:175]
    v_exp_f32 v23, v23
    v_mfma_f32_16x16x32_bf16 v[172:175], a[88:91], v[56:59], v[172:175]
    v_cvt_pk_bf16_f32 v51, v22, v23
    v_mfma_f32_16x16x32_bf16 v[176:179], a[96:99], v[56:59], v[176:179]
    v_exp_f32 v24, v24
    v_mfma_f32_16x16x32_bf16 v[176:179], a[100:103], v[60:63], v[176:179]
    v_mfma_f32_16x16x32_bf16 v[180:183], a[108:111], v[60:63], v[180:183]
    v_exp_f32 v25, v25
    v_mfma_f32_16x16x32_bf16 v[180:183], a[104:107], v[56:59], v[180:183]
    v_cvt_pk_bf16_f32 v52, v24, v25
    v_mfma_f32_16x16x32_bf16 v[184:187], a[112:115], v[56:59], v[184:187]
    v_exp_f32 v26, v26
    v_mfma_f32_16x16x32_bf16 v[184:187], a[116:119], v[60:63], v[184:187]
    v_mfma_f32_16x16x32_bf16 v[188:191], a[124:127], v[60:63], v[188:191]
    v_exp_f32 v27, v27
    v_mfma_f32_16x16x32_bf16 v[188:191], a[120:123], v[56:59], v[188:191]
    v_cvt_pk_bf16_f32 v53, v26, v27
    v_mfma_f32_16x16x32_bf16 v[32:35], a[0:3], a[176:179], v[76:79]
    v_exp_f32 v28, v28
    v_mfma_f32_16x16x32_bf16 v[32:35], a[4:7], a[180:183], v[32:35]
    ds_read_b128 a[0:3], v80 offset:0
    v_mfma_f32_16x16x32_bf16 v[32:35], a[8:11], a[184:187], v[32:35]
    v_exp_f32 v29, v29
    v_mfma_f32_16x16x32_bf16 v[32:35], a[12:15], a[188:191], v[32:35]
    ds_read_b128 a[4:7], v81 offset:0
    v_cvt_pk_bf16_f32 v54, v28, v29
    v_mfma_f32_16x16x32_bf16 v[36:39], a[28:31], a[188:191], v[76:79]
    v_exp_f32 v30, v30
    v_mfma_f32_16x16x32_bf16 v[36:39], a[24:27], a[184:187], v[36:39]
    ds_read_b128 a[8:11], v82 offset:0
    ds_read_b128 a[12:15], v83 offset:0
    v_mfma_f32_16x16x32_bf16 v[36:39], a[20:23], a[180:183], v[36:39]
    v_exp_f32 v31, v31
    v_mfma_f32_16x16x32_bf16 v[36:39], a[16:19], a[176:179], v[36:39]
    ds_read_b128 a[28:31], v83 offset:4096
    v_cvt_pk_bf16_f32 v55, v30, v31
    v_mfma_f32_16x16x32_bf16 v[40:43], a[32:35], a[176:179], v[76:79]
    ds_read_b128 a[24:27], v82 offset:4096
    ds_read_b128 a[20:23], v81 offset:4096
    v_mfma_f32_16x16x32_bf16 v[40:43], a[36:39], a[180:183], v[40:43]
    v_exp_f32 v32, v32
    v_mfma_f32_16x16x32_bf16 v[40:43], a[40:43], a[184:187], v[40:43]
    ds_read_b128 a[16:19], v80 offset:4096
    ds_read_b128 a[32:35], v80 offset:8192
    v_mfma_f32_16x16x32_bf16 v[40:43], a[44:47], a[188:191], v[40:43]
    v_exp_f32 v33, v33
    v_mfma_f32_16x16x32_bf16 v[44:47], a[60:63], a[188:191], v[76:79]
    ds_read_b128 a[36:39], v81 offset:8192
    v_cvt_pk_bf16_f32 v56, v32, v33
    v_mfma_f32_16x16x32_bf16 v[44:47], a[56:59], a[184:187], v[44:47]
    v_exp_f32 v34, v34
    v_mfma_f32_16x16x32_bf16 v[44:47], a[52:55], a[180:183], v[44:47]
    ds_read_b128 a[40:43], v82 offset:8192
    ds_read_b128 a[44:47], v83 offset:8192
    v_mfma_f32_16x16x32_bf16 v[44:47], a[48:51], a[176:179], v[44:47]
    v_exp_f32 v35, v35
    v_smfmac_f32_16x16x64_bf16 a[200:203], a[208:211], v[48:55], v101
    ds_read_b128 a[60:63], v83 offset:12288
    ds_read_b128 a[56:59], v82 offset:12288
    v_mfma_f32_16x16x32_bf16 v[192:195], a[64:67], v[48:51], v[192:195]
    v_exp_f32 v36, v36
    v_mfma_f32_16x16x32_bf16 v[192:195], a[68:71], v[52:55], v[192:195]
    ds_read_b128 a[52:55], v81 offset:12288
    v_cvt_pk_bf16_f32 v57, v34, v35
    v_mfma_f32_16x16x32_bf16 v[196:199], a[76:79], v[52:55], v[196:199]
    v_exp_f32 v37, v37
    v_mfma_f32_16x16x32_bf16 v[196:199], a[72:75], v[48:51], v[196:199]
    ds_read_b128 a[48:51], v80 offset:12288
    v_cvt_pk_bf16_f32 v58, v36, v37
    v_mfma_f32_16x16x32_bf16 v[200:203], a[80:83], v[48:51], v[200:203]
    v_exp_f32 v38, v38
    v_mfma_f32_16x16x32_bf16 v[200:203], a[84:87], v[52:55], v[200:203]
    v_mfma_f32_16x16x32_bf16 v[204:207], a[92:95], v[52:55], v[204:207]
    v_exp_f32 v39, v39
    v_mfma_f32_16x16x32_bf16 v[204:207], a[88:91], v[48:51], v[204:207]
    v_cvt_pk_bf16_f32 v59, v38, v39
    v_mfma_f32_16x16x32_bf16 v[208:211], a[96:99], v[48:51], v[208:211]
    v_exp_f32 v40, v40
    v_mfma_f32_16x16x32_bf16 v[208:211], a[100:103], v[52:55], v[208:211]
    v_exp_f32 v41, v41
    v_mfma_f32_16x16x32_bf16 v[212:215], a[108:111], v[52:55], v[212:215]
    v_cvt_pk_bf16_f32 v60, v40, v41
    v_mfma_f32_16x16x32_bf16 v[212:215], a[104:107], v[48:51], v[212:215]
    v_exp_f32 v42, v42
    v_mfma_f32_16x16x32_bf16 v[216:219], a[112:115], v[48:51], v[216:219]
    s_waitcnt lgkmcnt(0)
    v_mfma_f32_16x16x32_bf16 v[216:219], a[116:119], v[52:55], v[216:219]
    v_exp_f32 v43, v43
    v_mfma_f32_16x16x32_bf16 v[220:223], a[124:127], v[52:55], v[220:223]
    v_cvt_pk_bf16_f32 v61, v42, v43
    v_mfma_f32_16x16x32_bf16 v[220:223], a[120:123], v[48:51], v[220:223]
    s_cbranch_scc0 L_loop
L_last:
    v_mfma_f32_16x16x32_bf16 v[16:19], a[0:3], a[128:131], v[64:67]
    s_lshl_b32 s7, s3, 13
    v_exp_f32 v44, v44
    v_mfma_f32_16x16x32_bf16 v[16:19], a[4:7], a[132:135], v[16:19]
    s_add_u32 s7, s7, 131072
    v_exp_f32 v45, v45
    v_mfma_f32_16x16x32_bf16 v[16:19], a[8:11], a[136:139], v[16:19]
    v_cvt_pk_bf16_f32 v62, v44, v45
    v_add_u32 v84, s33, v84
    v_add_u32 v85, s33, v85
    v_mfma_f32_16x16x32_bf16 v[16:19], a[12:15], a[140:143], v[16:19]
    v_add_u32 v86, s33, v86
    v_add_u32 v87, s33, v87
    v_add_u32 v88, s33, v88
    v_mfma_f32_16x16x32_bf16 v[20:23], a[28:31], a[140:143], v[64:67]
    v_exp_f32 v46, v46
    v_mfma_f32_16x16x32_bf16 v[20:23], a[24:27], a[136:139], v[20:23]
    v_exp_f32 v47, v47
    v_mfma_f32_16x16x32_bf16 v[20:23], a[20:23], a[132:135], v[20:23]
    v_cvt_pk_bf16_f32 v63, v46, v47
    v_add_u32 v89, s33, v89
    v_add_u32 v90, s33, v90
    v_mfma_f32_16x16x32_bf16 v[20:23], a[16:19], a[128:131], v[20:23]
    v_add_u32 v91, s33, v91
    v_lshrrev_b32 v1, 5, v2
    v_and_b32 v11, 7, v4
    v_mfma_f32_16x16x32_bf16 v[24:27], a[32:35], a[128:131], v[64:67]
    v_exp_f32 v16, v16
    v_mfma_f32_16x16x32_bf16 v[24:27], a[36:39], a[132:135], v[24:27]
    v_exp_f32 v17, v17
    v_mfma_f32_16x16x32_bf16 v[24:27], a[40:43], a[136:139], v[24:27]
    v_cvt_pk_bf16_f32 v48, v16, v17
    v_xor_b32 v1, v1, v11
    v_and_b32 v11, 1, v3
    v_mfma_f32_16x16x32_bf16 v[24:27], a[44:47], a[140:143], v[24:27]
    v_lshl_add_u32 v1, v11, 3, v1
    v_lshlrev_b32 v1, 4, v1
    v_lshl_add_u32 v1, v4, 8, v1
    v_mfma_f32_16x16x32_bf16 v[28:31], a[60:63], a[140:143], v[64:67]
    v_exp_f32 v18, v18
    v_mfma_f32_16x16x32_bf16 v[28:31], a[56:59], a[136:139], v[28:31]
    v_exp_f32 v19, v19
    v_mfma_f32_16x16x32_bf16 v[28:31], a[52:55], a[132:135], v[28:31]
    v_exp_f32 v20, v20
    v_mfma_f32_16x16x32_bf16 v[28:31], a[48:51], a[128:131], v[28:31]
    v_cvt_pk_bf16_f32 v49, v18, v19
    v_add_u32 v120, s7, v1
    v_xor_b32 v121, 32, v120
    v_smfmac_f32_16x16x64_bf16 a[204:207], a[208:211], v[56:63], v101
    v_xor_b32 v122, 64, v120
    v_mfma_f32_16x16x32_bf16 v[224:227], a[64:67], v[56:59], v[224:227]
    v_exp_f32 v21, v21
    v_mfma_f32_16x16x32_bf16 v[224:227], a[68:71], v[60:63], v[224:227]
    ds_read_b64_tr_b16 a[64:65], v84 offset:0
    v_cvt_pk_bf16_f32 v50, v20, v21
    v_xor_b32 v123, 96, v120
    v_mfma_f32_16x16x32_bf16 v[228:231], a[76:79], v[60:63], v[228:231]
    ds_read_b64_tr_b16 a[66:67], v84 offset:4096
    ds_read_b64_tr_b16 a[68:69], v84 offset:8192
    v_lshrrev_b32 v1, 2, v4
    v_mfma_f32_16x16x32_bf16 v[228:231], a[72:75], v[56:59], v[228:231]
    v_exp_f32 v22, v22
    v_mfma_f32_16x16x32_bf16 v[232:235], a[80:83], v[56:59], v[232:235]
    ds_read_b64_tr_b16 a[70:71], v84 offset:12288
    ds_read_b64_tr_b16 a[76:77], v85 offset:8192
    v_and_b32 v11, 1, v4
    v_mfma_f32_16x16x32_bf16 v[232:235], a[84:87], v[60:63], v[232:235]
    v_exp_f32 v23, v23
    v_mfma_f32_16x16x32_bf16 v[236:239], a[92:95], v[60:63], v[236:239]
    ds_read_b64_tr_b16 a[78:79], v85 offset:12288
    v_cvt_pk_bf16_f32 v51, v22, v23
    v_lshl_add_u32 v1, v1, 1, v11
    v_mfma_f32_16x16x32_bf16 v[236:239], a[88:91], v[56:59], v[236:239]
    ds_read_b64_tr_b16 a[72:73], v85 offset:0
    ds_read_b64_tr_b16 a[74:75], v85 offset:4096
    v_xor_b32 v1, v1, v3
    v_mfma_f32_16x16x32_bf16 v[240:243], a[96:99], v[56:59], v[240:243]
    v_exp_f32 v24, v24
    v_mfma_f32_16x16x32_bf16 v[240:243], a[100:103], v[60:63], v[240:243]
    ds_read_b64_tr_b16 a[80:81], v86 offset:0
    ds_read_b64_tr_b16 a[82:83], v86 offset:4096
    v_bfe_u32 v11, v4, 1, 1
    v_mfma_f32_16x16x32_bf16 v[244:247], a[108:111], v[60:63], v[244:247]
    v_exp_f32 v25, v25
    v_mfma_f32_16x16x32_bf16 v[244:247], a[104:107], v[56:59], v[244:247]
    ds_read_b64_tr_b16 a[84:85], v86 offset:8192
    v_cvt_pk_bf16_f32 v52, v24, v25
    v_lshl_add_u32 v1, v1, 1, v11
    v_mfma_f32_16x16x32_bf16 v[248:251], a[112:115], v[56:59], v[248:251]
    ds_read_b64_tr_b16 a[86:87], v86 offset:12288
    ds_read_b64_tr_b16 a[92:93], v87 offset:8192
    v_lshlrev_b32 v1, 3, v1
    v_mfma_f32_16x16x32_bf16 v[248:251], a[116:119], v[60:63], v[248:251]
    v_exp_f32 v26, v26
    v_mfma_f32_16x16x32_bf16 v[252:255], a[124:127], v[60:63], v[252:255]
    ds_read_b64_tr_b16 a[94:95], v87 offset:12288
    ds_read_b64_tr_b16 a[88:89], v87 offset:0
    v_lshl_add_u32 v1, v3, 8, v1
    v_mfma_f32_16x16x32_bf16 v[252:255], a[120:123], v[56:59], v[252:255]
    v_exp_f32 v27, v27
    v_mfma_f32_16x16x32_bf16 v[32:35], a[0:3], a[144:147], v[68:71]
    ds_read_b64_tr_b16 a[90:91], v87 offset:4096
    v_cvt_pk_bf16_f32 v53, v26, v27
    v_add_u32 v5, s7, v1
    v_mfma_f32_16x16x32_bf16 v[32:35], a[4:7], a[148:151], v[32:35]
    ds_read_b64_tr_b16 a[96:97], v88 offset:0
    ds_read_b64_tr_b16 a[98:99], v88 offset:4096
    v_xor_b32 v6, 0x440, v5
    v_mfma_f32_16x16x32_bf16 v[32:35], a[8:11], a[152:155], v[32:35]
    v_exp_f32 v28, v28
    v_mfma_f32_16x16x32_bf16 v[32:35], a[12:15], a[156:159], v[32:35]
    ds_read_b64_tr_b16 a[100:101], v88 offset:8192
    ds_read_b64_tr_b16 a[102:103], v88 offset:12288
    v_xor_b32 v7, 0x800, v5
    v_mfma_f32_16x16x32_bf16 v[36:39], a[28:31], a[156:159], v[68:71]
    v_exp_f32 v29, v29
    v_mfma_f32_16x16x32_bf16 v[36:39], a[24:27], a[152:155], v[36:39]
    ds_read_b64_tr_b16 a[108:109], v89 offset:8192
    v_cvt_pk_bf16_f32 v54, v28, v29
    v_xor_b32 v8, 0xc40, v5
    v_mfma_f32_16x16x32_bf16 v[36:39], a[20:23], a[148:151], v[36:39]
    ds_read_b64_tr_b16 a[110:111], v89 offset:12288
    ds_read_b64_tr_b16 a[104:105], v89 offset:0
    v_xor_b32 v124, 0x1000, v5
    v_mfma_f32_16x16x32_bf16 v[36:39], a[16:19], a[144:147], v[36:39]
    v_exp_f32 v30, v30
    v_mfma_f32_16x16x32_bf16 v[40:43], a[32:35], a[144:147], v[68:71]
    ds_read_b64_tr_b16 a[106:107], v89 offset:4096
    ds_read_b64_tr_b16 a[112:113], v90 offset:0
    v_xor_b32 v125, 0x1000, v6
    v_mfma_f32_16x16x32_bf16 v[40:43], a[36:39], a[148:151], v[40:43]
    v_exp_f32 v31, v31
    v_mfma_f32_16x16x32_bf16 v[40:43], a[40:43], a[152:155], v[40:43]
    ds_read_b64_tr_b16 a[114:115], v90 offset:4096
    v_cvt_pk_bf16_f32 v55, v30, v31
    v_xor_b32 v126, 0x1000, v7
    v_mfma_f32_16x16x32_bf16 v[40:43], a[44:47], a[156:159], v[40:43]
    ds_read_b64_tr_b16 a[116:117], v90 offset:8192
    ds_read_b64_tr_b16 a[118:119], v90 offset:12288
    v_xor_b32 v127, 0x1000, v8
    v_mfma_f32_16x16x32_bf16 v[44:47], a[60:63], a[156:159], v[68:71]
    v_exp_f32 v32, v32
    v_mfma_f32_16x16x32_bf16 v[44:47], a[56:59], a[152:155], v[44:47]
    ds_read_b64_tr_b16 a[124:125], v91 offset:8192
    ds_read_b64_tr_b16 a[126:127], v91 offset:12288
    v_lshlrev_b32 v9, 4, v2
    v_mfma_f32_16x16x32_bf16 v[44:47], a[52:55], a[148:151], v[44:47]
    v_exp_f32 v33, v33
    v_mfma_f32_16x16x32_bf16 v[44:47], a[48:51], a[144:147], v[44:47]
    ds_read_b64_tr_b16 a[120:121], v91 offset:0
    v_cvt_pk_bf16_f32 v56, v32, v33
    v_mov_b32 v103, 0x4e800000
    v_smfmac_f32_16x16x64_bf16 a[192:195], a[208:211], v[48:55], v101
    s_waitcnt lgkmcnt(7)
    ds_read_b64_tr_b16 a[122:123], v91 offset:4096
    v_mfma_f32_16x16x32_bf16 v[128:131], a[64:67], v[48:51], v[128:131]
    v_exp_f32 v34, v34
    v_mfma_f32_16x16x32_bf16 v[128:131], a[68:71], v[52:55], v[128:131]
    v_exp_f32 v35, v35
    v_mfma_f32_16x16x32_bf16 v[132:135], a[76:79], v[52:55], v[132:135]
    v_cvt_pk_bf16_f32 v57, v34, v35
    v_accvgpr_read_b32 v117, a228
    v_mfma_f32_16x16x32_bf16 v[132:135], a[72:75], v[48:51], v[132:135]
    v_exp_f32 v36, v36
    v_mfma_f32_16x16x32_bf16 v[136:139], a[80:83], v[48:51], v[136:139]
    v_exp_f32 v37, v37
    v_mfma_f32_16x16x32_bf16 v[136:139], a[84:87], v[52:55], v[136:139]
    v_cvt_pk_bf16_f32 v58, v36, v37
    v_accvgpr_read_b32 v112, a192
    v_accvgpr_read_b32 v116, a193
    v_mfma_f32_16x16x32_bf16 v[140:143], a[92:95], v[52:55], v[140:143]
    v_exp_f32 v38, v38
    v_mfma_f32_16x16x32_bf16 v[140:143], a[88:91], v[48:51], v[140:143]
    s_waitcnt lgkmcnt(0)
    v_exp_f32 v39, v39
    v_mfma_f32_16x16x32_bf16 v[144:147], a[96:99], v[48:51], v[144:147]
    s_barrier
    v_add_f32 v112, v112, v116
    v_rcp_f32 v104, v112
    v_mfma_f32_16x16x32_bf16 v[144:147], a[100:103], v[52:55], v[144:147]
    v_cvt_pk_bf16_f32 v59, v38, v39
    v_mul_f32_e64 v105, -v117, v104
    v_fma_f32 v128, v128, v104, v105
    v_fma_f32 v129, v129, v104, v105
    v_fma_f32 v130, v130, v104, v105
    v_fma_f32 v131, v131, v104, v105
    v_fma_f32 v132, v132, v104, v105
    v_fma_f32 v133, v133, v104, v105
    v_mfma_f32_16x16x32_bf16 v[148:151], a[108:111], v[52:55], v[148:151]
    v_fma_f32 v134, v134, v104, v105
    v_fma_f32 v135, v135, v104, v105
    v_cvt_pk_bf16_f32 v128, v128, v129
    v_cvt_pk_bf16_f32 v129, v130, v131
    v_cvt_pk_bf16_f32 v130, v132, v133
    v_cvt_pk_bf16_f32 v131, v134, v135
    v_mfma_f32_16x16x32_bf16 v[148:151], a[104:107], v[48:51], v[148:151]
    v_exp_f32 v40, v40
    v_mfma_f32_16x16x32_bf16 v[152:155], a[112:115], v[48:51], v[152:155]
    v_exp_f32 v41, v41
    v_mfma_f32_16x16x32_bf16 v[152:155], a[116:119], v[52:55], v[152:155]
    v_cvt_pk_bf16_f32 v60, v40, v41
    v_fma_f32 v136, v136, v104, v105
    v_fma_f32 v137, v137, v104, v105
    v_fma_f32 v138, v138, v104, v105
    v_fma_f32 v139, v139, v104, v105
    v_fma_f32 v140, v140, v104, v105
    v_fma_f32 v141, v141, v104, v105
    v_mfma_f32_16x16x32_bf16 v[156:159], a[124:127], v[52:55], v[156:159]
    ds_write_b128 v120, v[128:131] offset:0
    v_exp_f32 v42, v42
    v_fma_f32 v142, v142, v104, v105
    v_fma_f32 v143, v143, v104, v105
    v_cvt_pk_bf16_f32 v136, v136, v137
    v_mfma_f32_16x16x32_bf16 v[156:159], a[120:123], v[48:51], v[156:159]
    v_exp_f32 v43, v43
    v_cvt_pk_bf16_f32 v137, v138, v139
    v_cvt_pk_bf16_f32 v138, v140, v141
    v_cvt_pk_bf16_f32 v139, v142, v143
    v_mfma_f32_16x16x32_bf16 v[16:19], a[0:3], a[160:163], v[72:75]
    v_cvt_pk_bf16_f32 v61, v42, v43
    v_mfma_f32_16x16x32_bf16 v[16:19], a[4:7], a[164:167], v[16:19]
    v_fma_f32 v144, v144, v104, v105
    v_fma_f32 v145, v145, v104, v105
    v_fma_f32 v146, v146, v104, v105
    v_fma_f32 v147, v147, v104, v105
    v_fma_f32 v148, v148, v104, v105
    v_fma_f32 v149, v149, v104, v105
    v_mfma_f32_16x16x32_bf16 v[16:19], a[8:11], a[168:171], v[16:19]
    ds_write_b128 v121, v[136:139] offset:0
    v_exp_f32 v44, v44
    v_fma_f32 v150, v150, v104, v105
    v_fma_f32 v151, v151, v104, v105
    v_cvt_pk_bf16_f32 v144, v144, v145
    v_mfma_f32_16x16x32_bf16 v[16:19], a[12:15], a[172:175], v[16:19]
    v_exp_f32 v45, v45
    v_cvt_pk_bf16_f32 v145, v146, v147
    v_cvt_pk_bf16_f32 v146, v148, v149
    v_cvt_pk_bf16_f32 v147, v150, v151
    v_mfma_f32_16x16x32_bf16 v[20:23], a[28:31], a[172:175], v[72:75]
    v_cvt_pk_bf16_f32 v62, v44, v45
    v_mfma_f32_16x16x32_bf16 v[20:23], a[24:27], a[168:171], v[20:23]
    v_exp_f32 v46, v46
    v_fma_f32 v152, v152, v104, v105
    v_fma_f32 v153, v153, v104, v105
    v_fma_f32 v154, v154, v104, v105
    v_fma_f32 v155, v155, v104, v105
    v_mfma_f32_16x16x32_bf16 v[20:23], a[20:23], a[164:167], v[20:23]
    v_exp_f32 v47, v47
    v_fma_f32 v156, v156, v104, v105
    v_fma_f32 v157, v157, v104, v105
    v_mfma_f32_16x16x32_bf16 v[20:23], a[16:19], a[160:163], v[20:23]
    ds_write_b128 v122, v[144:147] offset:0
    v_cvt_pk_bf16_f32 v63, v46, v47
    v_fma_f32 v158, v158, v104, v105
    v_fma_f32 v159, v159, v104, v105
    v_cvt_pk_bf16_f32 v152, v152, v153
    v_cvt_pk_bf16_f32 v153, v154, v155
    v_cvt_pk_bf16_f32 v154, v156, v157
    v_cvt_pk_bf16_f32 v155, v158, v159
    v_mfma_f32_16x16x32_bf16 v[24:27], a[32:35], a[160:163], v[72:75]
    ds_write_b128 v123, v[152:155] offset:0
    ds_read2_b64 v[132:135], v5 offset0:0 offset1:16
    v_mfma_f32_16x16x32_bf16 v[24:27], a[36:39], a[164:167], v[24:27]
    ds_read2_b64 v[140:143], v6 offset0:0 offset1:16
    ds_read2_b64 v[148:151], v7 offset0:0 offset1:16
    v_exp_f32 v16, v16
    v_mfma_f32_16x16x32_bf16 v[24:27], a[40:43], a[168:171], v[24:27]
    ds_read2_b64 v[156:159], v8 offset0:0 offset1:16
    v_exp_f32 v17, v17
    v_mfma_f32_16x16x32_bf16 v[24:27], a[44:47], a[172:175], v[24:27]
    v_cvt_pk_bf16_f32 v48, v16, v17
    v_mfma_f32_16x16x32_bf16 v[28:31], a[60:63], a[172:175], v[72:75]
    v_mfma_f32_16x16x32_bf16 v[28:31], a[56:59], a[168:171], v[28:31]
    v_exp_f32 v18, v18
    v_mfma_f32_16x16x32_bf16 v[28:31], a[52:55], a[164:167], v[28:31]
    v_exp_f32 v19, v19
    v_mfma_f32_16x16x32_bf16 v[28:31], a[48:51], a[160:163], v[28:31]
    s_waitcnt lgkmcnt(0)
    v_cvt_pk_bf16_f32 v49, v18, v19
    v_smfmac_f32_16x16x64_bf16 a[196:199], a[208:211], v[56:63], v101
    buffer_store_dwordx4 v[132:135], v9, s[48:51], s14 offen sc0 sc1 nt
    v_mfma_f32_16x16x32_bf16 v[160:163], a[64:67], v[56:59], v[160:163]
    v_exp_f32 v20, v20
    v_mfma_f32_16x16x32_bf16 v[160:163], a[68:71], v[60:63], v[160:163]
    v_exp_f32 v21, v21
    v_mfma_f32_16x16x32_bf16 v[164:167], a[76:79], v[60:63], v[164:167]
    v_cvt_pk_bf16_f32 v50, v20, v21
    v_mfma_f32_16x16x32_bf16 v[164:167], a[72:75], v[56:59], v[164:167]
    buffer_store_dwordx4 v[140:143], v9, s[48:51], s14 offen offset:1024 sc0 sc1 nt
    v_mfma_f32_16x16x32_bf16 v[168:171], a[80:83], v[56:59], v[168:171]
    v_exp_f32 v22, v22
    v_mfma_f32_16x16x32_bf16 v[168:171], a[84:87], v[60:63], v[168:171]
    v_exp_f32 v23, v23
    v_accvgpr_read_b32 v113, a196
    v_accvgpr_read_b32 v116, a197
    v_add_f32 v113, v113, v116
    v_mfma_f32_16x16x32_bf16 v[172:175], a[92:95], v[60:63], v[172:175]
    v_cvt_pk_bf16_f32 v51, v22, v23
    v_mfma_f32_16x16x32_bf16 v[172:175], a[88:91], v[56:59], v[172:175]
    buffer_store_dwordx4 v[148:151], v9, s[48:51], s14 offen offset:2048 sc0 sc1 nt
    v_mfma_f32_16x16x32_bf16 v[176:179], a[96:99], v[56:59], v[176:179]
    v_exp_f32 v24, v24
    v_rcp_f32 v106, v113
    v_mfma_f32_16x16x32_bf16 v[176:179], a[100:103], v[60:63], v[176:179]
    v_exp_f32 v25, v25
    v_mul_f32_e64 v107, -v117, v106
    v_fma_f32 v160, v160, v106, v107
    v_fma_f32 v161, v161, v106, v107
    v_fma_f32 v162, v162, v106, v107
    v_mfma_f32_16x16x32_bf16 v[180:183], a[108:111], v[60:63], v[180:183]
    v_cvt_pk_bf16_f32 v52, v24, v25
    v_mfma_f32_16x16x32_bf16 v[180:183], a[104:107], v[56:59], v[180:183]
    buffer_store_dwordx4 v[156:159], v9, s[48:51], s14 offen offset:3072 sc0 sc1 nt
    v_mfma_f32_16x16x32_bf16 v[184:187], a[112:115], v[56:59], v[184:187]
    v_exp_f32 v26, v26
    v_fma_f32 v163, v163, v106, v107
    v_fma_f32 v164, v164, v106, v107
    v_fma_f32 v165, v165, v106, v107
    v_fma_f32 v166, v166, v106, v107
    v_mfma_f32_16x16x32_bf16 v[184:187], a[116:119], v[60:63], v[184:187]
    v_exp_f32 v27, v27
    v_fma_f32 v167, v167, v106, v107
    v_cvt_pk_bf16_f32 v160, v160, v161
    v_cvt_pk_bf16_f32 v161, v162, v163
    v_cvt_pk_bf16_f32 v162, v164, v165
    v_mfma_f32_16x16x32_bf16 v[188:191], a[124:127], v[60:63], v[188:191]
    v_cvt_pk_bf16_f32 v53, v26, v27
    v_cvt_pk_bf16_f32 v163, v166, v167
    v_fma_f32 v168, v168, v106, v107
    v_fma_f32 v169, v169, v106, v107
    v_fma_f32 v170, v170, v106, v107
    v_fma_f32 v171, v171, v106, v107
    v_fma_f32 v172, v172, v106, v107
    v_fma_f32 v173, v173, v106, v107
    v_mfma_f32_16x16x32_bf16 v[188:191], a[120:123], v[56:59], v[188:191]
    ds_write_b128 v120, v[160:163] offset:4096
    v_fma_f32 v174, v174, v106, v107
    v_fma_f32 v175, v175, v106, v107
    v_cvt_pk_bf16_f32 v168, v168, v169
    v_cvt_pk_bf16_f32 v169, v170, v171
    v_cvt_pk_bf16_f32 v170, v172, v173
    v_cvt_pk_bf16_f32 v171, v174, v175
    v_mfma_f32_16x16x32_bf16 v[32:35], a[0:3], a[176:179], v[76:79]
    v_exp_f32 v28, v28
    v_mfma_f32_16x16x32_bf16 v[32:35], a[4:7], a[180:183], v[32:35]
    v_fma_f32 v176, v176, v106, v107
    v_fma_f32 v177, v177, v106, v107
    v_fma_f32 v178, v178, v106, v107
    v_fma_f32 v179, v179, v106, v107
    v_fma_f32 v180, v180, v106, v107
    v_fma_f32 v181, v181, v106, v107
    v_mfma_f32_16x16x32_bf16 v[32:35], a[8:11], a[184:187], v[32:35]
    ds_write_b128 v121, v[168:171] offset:4096
    v_exp_f32 v29, v29
    v_fma_f32 v182, v182, v106, v107
    v_fma_f32 v183, v183, v106, v107
    v_cvt_pk_bf16_f32 v176, v176, v177
    v_mfma_f32_16x16x32_bf16 v[32:35], a[12:15], a[188:191], v[32:35]
    v_cvt_pk_bf16_f32 v54, v28, v29
    v_cvt_pk_bf16_f32 v177, v178, v179
    v_cvt_pk_bf16_f32 v178, v180, v181
    v_cvt_pk_bf16_f32 v179, v182, v183
    v_mfma_f32_16x16x32_bf16 v[36:39], a[28:31], a[188:191], v[76:79]
    v_exp_f32 v30, v30
    v_mfma_f32_16x16x32_bf16 v[36:39], a[24:27], a[184:187], v[36:39]
    v_fma_f32 v184, v184, v106, v107
    v_fma_f32 v185, v185, v106, v107
    v_fma_f32 v186, v186, v106, v107
    v_fma_f32 v187, v187, v106, v107
    v_fma_f32 v188, v188, v106, v107
    v_fma_f32 v189, v189, v106, v107
    v_mfma_f32_16x16x32_bf16 v[36:39], a[20:23], a[180:183], v[36:39]
    ds_write_b128 v122, v[176:179] offset:4096
    v_exp_f32 v31, v31
    v_fma_f32 v190, v190, v106, v107
    v_fma_f32 v191, v191, v106, v107
    v_cvt_pk_bf16_f32 v184, v184, v185
    v_mfma_f32_16x16x32_bf16 v[36:39], a[16:19], a[176:179], v[36:39]
    v_cvt_pk_bf16_f32 v55, v30, v31
    v_cvt_pk_bf16_f32 v185, v186, v187
    v_cvt_pk_bf16_f32 v186, v188, v189
    v_cvt_pk_bf16_f32 v187, v190, v191
    v_mfma_f32_16x16x32_bf16 v[40:43], a[32:35], a[176:179], v[76:79]
    ds_write_b128 v123, v[184:187] offset:4096
    ds_read2_b64 v[164:167], v124 offset0:0 offset1:16
    v_exp_f32 v32, v32
    v_mfma_f32_16x16x32_bf16 v[40:43], a[36:39], a[180:183], v[40:43]
    ds_read2_b64 v[172:175], v125 offset0:0 offset1:16
    ds_read2_b64 v[180:183], v126 offset0:0 offset1:16
    v_exp_f32 v33, v33
    v_mfma_f32_16x16x32_bf16 v[40:43], a[40:43], a[184:187], v[40:43]
    ds_read2_b64 v[188:191], v127 offset0:0 offset1:16
    v_exp_f32 v34, v34
    v_cvt_pk_bf16_f32 v56, v32, v33
    v_mfma_f32_16x16x32_bf16 v[40:43], a[44:47], a[188:191], v[40:43]
    v_exp_f32 v35, v35
    v_mfma_f32_16x16x32_bf16 v[44:47], a[60:63], a[188:191], v[76:79]
    v_cvt_pk_bf16_f32 v57, v34, v35
    v_mfma_f32_16x16x32_bf16 v[44:47], a[56:59], a[184:187], v[44:47]
    v_mfma_f32_16x16x32_bf16 v[44:47], a[52:55], a[180:183], v[44:47]
    v_exp_f32 v36, v36
    v_mfma_f32_16x16x32_bf16 v[44:47], a[48:51], a[176:179], v[44:47]
    v_exp_f32 v37, v37
    v_smfmac_f32_16x16x64_bf16 a[200:203], a[208:211], v[48:55], v101
    v_exp_f32 v38, v38
    v_cvt_pk_bf16_f32 v58, v36, v37
    v_mfma_f32_16x16x32_bf16 v[192:195], a[64:67], v[48:51], v[192:195]
    v_exp_f32 v39, v39
    v_mfma_f32_16x16x32_bf16 v[192:195], a[68:71], v[52:55], v[192:195]
    s_waitcnt lgkmcnt(0)
    v_cvt_pk_bf16_f32 v59, v38, v39
    v_mfma_f32_16x16x32_bf16 v[196:199], a[76:79], v[52:55], v[196:199]
    buffer_store_dwordx4 v[164:167], v9, s[48:51], s45 offen sc0 sc1 nt
    v_mfma_f32_16x16x32_bf16 v[196:199], a[72:75], v[48:51], v[196:199]
    v_exp_f32 v40, v40
    v_mfma_f32_16x16x32_bf16 v[200:203], a[80:83], v[48:51], v[200:203]
    v_exp_f32 v41, v41
    v_mfma_f32_16x16x32_bf16 v[200:203], a[84:87], v[52:55], v[200:203]
    v_exp_f32 v42, v42
    v_cvt_pk_bf16_f32 v60, v40, v41
    v_accvgpr_read_b32 v114, a200
    v_accvgpr_read_b32 v116, a201
    v_add_f32 v114, v114, v116
    v_mfma_f32_16x16x32_bf16 v[204:207], a[92:95], v[52:55], v[204:207]
    v_exp_f32 v43, v43
    v_rcp_f32 v108, v114
    v_mfma_f32_16x16x32_bf16 v[204:207], a[88:91], v[48:51], v[204:207]
    v_cvt_pk_bf16_f32 v61, v42, v43
    v_mfma_f32_16x16x32_bf16 v[208:211], a[96:99], v[48:51], v[208:211]
    buffer_store_dwordx4 v[172:175], v9, s[48:51], s45 offen offset:1024 sc0 sc1 nt
    v_mfma_f32_16x16x32_bf16 v[208:211], a[100:103], v[52:55], v[208:211]
    v_exp_f32 v44, v44
    v_mul_f32_e64 v109, -v117, v108
    v_fma_f32 v192, v192, v108, v109
    v_fma_f32 v193, v193, v108, v109
    v_fma_f32 v194, v194, v108, v109
    v_mfma_f32_16x16x32_bf16 v[212:215], a[108:111], v[52:55], v[212:215]
    v_exp_f32 v45, v45
    v_fma_f32 v195, v195, v108, v109
    v_fma_f32 v196, v196, v108, v109
    v_fma_f32 v197, v197, v108, v109
    v_fma_f32 v198, v198, v108, v109
    v_mfma_f32_16x16x32_bf16 v[212:215], a[104:107], v[48:51], v[212:215]
    v_exp_f32 v46, v46
    v_cvt_pk_bf16_f32 v62, v44, v45
    v_fma_f32 v199, v199, v108, v109
    v_cvt_pk_bf16_f32 v192, v192, v193
    v_cvt_pk_bf16_f32 v193, v194, v195
    v_mfma_f32_16x16x32_bf16 v[216:219], a[112:115], v[48:51], v[216:219]
    v_exp_f32 v47, v47
    v_cvt_pk_bf16_f32 v194, v196, v197
    v_cvt_pk_bf16_f32 v195, v198, v199
    v_mfma_f32_16x16x32_bf16 v[216:219], a[116:119], v[52:55], v[216:219]
    v_cvt_pk_bf16_f32 v63, v46, v47
    v_mfma_f32_16x16x32_bf16 v[220:223], a[124:127], v[52:55], v[220:223]
    buffer_store_dwordx4 v[180:183], v9, s[48:51], s45 offen offset:2048 sc0 sc1 nt
    v_mfma_f32_16x16x32_bf16 v[220:223], a[120:123], v[48:51], v[220:223]
    v_fma_f32 v200, v200, v108, v109
    v_smfmac_f32_16x16x64_bf16 a[204:207], a[208:211], v[56:63], v101
    buffer_store_dwordx4 v[188:191], v9, s[48:51], s45 offen offset:3072 sc0 sc1 nt
    v_mfma_f32_16x16x32_bf16 v[224:227], a[64:67], v[56:59], v[224:227]
    v_fma_f32 v201, v201, v108, v109
    v_fma_f32 v202, v202, v108, v109
    v_fma_f32 v203, v203, v108, v109
    v_fma_f32 v204, v204, v108, v109
    v_fma_f32 v205, v205, v108, v109
    v_mfma_f32_16x16x32_bf16 v[224:227], a[68:71], v[60:63], v[224:227]
    ds_write_b128 v120, v[192:195] offset:0
    v_fma_f32 v206, v206, v108, v109
    v_fma_f32 v207, v207, v108, v109
    v_cvt_pk_bf16_f32 v200, v200, v201
    v_cvt_pk_bf16_f32 v201, v202, v203
    v_cvt_pk_bf16_f32 v202, v204, v205
    v_cvt_pk_bf16_f32 v203, v206, v207
    v_fma_f32 v208, v208, v108, v109
    v_mfma_f32_16x16x32_bf16 v[228:231], a[76:79], v[60:63], v[228:231]
    v_fma_f32 v209, v209, v108, v109
    v_fma_f32 v210, v210, v108, v109
    v_fma_f32 v211, v211, v108, v109
    v_fma_f32 v212, v212, v108, v109
    v_fma_f32 v213, v213, v108, v109
    v_mfma_f32_16x16x32_bf16 v[228:231], a[72:75], v[56:59], v[228:231]
    ds_write_b128 v121, v[200:203] offset:0
    v_fma_f32 v214, v214, v108, v109
    v_fma_f32 v215, v215, v108, v109
    v_cvt_pk_bf16_f32 v208, v208, v209
    v_cvt_pk_bf16_f32 v209, v210, v211
    v_cvt_pk_bf16_f32 v210, v212, v213
    v_cvt_pk_bf16_f32 v211, v214, v215
    v_mfma_f32_16x16x32_bf16 v[232:235], a[80:83], v[56:59], v[232:235]
    v_fma_f32 v216, v216, v108, v109
    v_fma_f32 v217, v217, v108, v109
    v_fma_f32 v218, v218, v108, v109
    v_fma_f32 v219, v219, v108, v109
    v_fma_f32 v220, v220, v108, v109
    v_fma_f32 v221, v221, v108, v109
    v_mfma_f32_16x16x32_bf16 v[232:235], a[84:87], v[60:63], v[232:235]
    ds_write_b128 v122, v[208:211] offset:0
    v_fma_f32 v222, v222, v108, v109
    v_fma_f32 v223, v223, v108, v109
    v_cvt_pk_bf16_f32 v216, v216, v217
    v_cvt_pk_bf16_f32 v217, v218, v219
    v_cvt_pk_bf16_f32 v218, v220, v221
    v_cvt_pk_bf16_f32 v219, v222, v223
    v_mfma_f32_16x16x32_bf16 v[236:239], a[92:95], v[60:63], v[236:239]
    ds_write_b128 v123, v[216:219] offset:0
    ds_read2_b64 v[196:199], v5 offset0:0 offset1:16
    v_mfma_f32_16x16x32_bf16 v[236:239], a[88:91], v[56:59], v[236:239]
    ds_read2_b64 v[204:207], v6 offset0:0 offset1:16
    ds_read2_b64 v[212:215], v7 offset0:0 offset1:16
    v_mfma_f32_16x16x32_bf16 v[240:243], a[96:99], v[56:59], v[240:243]
    ds_read2_b64 v[220:223], v8 offset0:0 offset1:16
    v_accvgpr_read_b32 v115, a204
    v_accvgpr_read_b32 v116, a205
    v_add_f32 v115, v115, v116
    v_rcp_f32 v110, v115
    v_mfma_f32_16x16x32_bf16 v[240:243], a[100:103], v[60:63], v[240:243]
    v_mul_f32_e64 v111, -v117, v110
    v_fma_f32 v224, v224, v110, v111
    v_fma_f32 v225, v225, v110, v111
    v_fma_f32 v226, v226, v110, v111
    v_fma_f32 v227, v227, v110, v111
    v_fma_f32 v228, v228, v110, v111
    v_fma_f32 v229, v229, v110, v111
    v_fma_f32 v230, v230, v110, v111
    v_mfma_f32_16x16x32_bf16 v[244:247], a[108:111], v[60:63], v[244:247]
    v_fma_f32 v231, v231, v110, v111
    v_cvt_pk_bf16_f32 v224, v224, v225
    v_cvt_pk_bf16_f32 v225, v226, v227
    v_cvt_pk_bf16_f32 v226, v228, v229
    v_cvt_pk_bf16_f32 v227, v230, v231
    v_mfma_f32_16x16x32_bf16 v[244:247], a[104:107], v[56:59], v[244:247]
    v_mfma_f32_16x16x32_bf16 v[248:251], a[112:115], v[56:59], v[248:251]
    s_waitcnt lgkmcnt(0)
    v_mfma_f32_16x16x32_bf16 v[248:251], a[116:119], v[60:63], v[248:251]
    buffer_store_dwordx4 v[196:199], v9, s[48:51], s46 offen sc0 sc1 nt
    v_mfma_f32_16x16x32_bf16 v[252:255], a[124:127], v[60:63], v[252:255]
    v_fma_f32 v232, v232, v110, v111
    v_mfma_f32_16x16x32_bf16 v[252:255], a[120:123], v[56:59], v[252:255]
    buffer_store_dwordx4 v[204:207], v9, s[48:51], s46 offen offset:1024 sc0 sc1 nt
    v_max3_f32 v1, v112, v113, v114
    v_add_f32 v11, v112, v113
    v_max_f32 v1, v1, v115
    v_add_f32 v10, v114, v115
    v_cmp_nle_f32 vcc, v1, v103
    v_add_f32 v11, v11, v10
    v_cmp_u_f32 s[60:61], v11, v11
    s_nop 0
    s_or_b64 vcc, vcc, s[60:61]
    s_cbranch_vccnz L_slow
    v_fma_f32 v233, v233, v110, v111
    v_fma_f32 v234, v234, v110, v111
    v_fma_f32 v235, v235, v110, v111
    v_fma_f32 v236, v236, v110, v111
    v_fma_f32 v237, v237, v110, v111
    ds_write_b128 v120, v[224:227] offset:4096
    v_fma_f32 v238, v238, v110, v111
    v_fma_f32 v239, v239, v110, v111
    v_cvt_pk_bf16_f32 v232, v232, v233
    v_cvt_pk_bf16_f32 v233, v234, v235
    v_cvt_pk_bf16_f32 v234, v236, v237
    v_cvt_pk_bf16_f32 v235, v238, v239
    v_fma_f32 v240, v240, v110, v111
    v_fma_f32 v241, v241, v110, v111
    v_fma_f32 v242, v242, v110, v111
    v_fma_f32 v243, v243, v110, v111
    v_fma_f32 v244, v244, v110, v111
    v_fma_f32 v245, v245, v110, v111
    buffer_store_dwordx4 v[212:215], v9, s[48:51], s46 offen offset:2048 sc0 sc1 nt
    ds_write_b128 v121, v[232:235] offset:4096
    v_fma_f32 v246, v246, v110, v111
    v_fma_f32 v247, v247, v110, v111
    v_cvt_pk_bf16_f32 v240, v240, v241
    v_cvt_pk_bf16_f32 v241, v242, v243
    v_cvt_pk_bf16_f32 v242, v244, v245
    buffer_store_dwordx4 v[220:223], v9, s[48:51], s46 offen offset:3072 sc0 sc1 nt
    v_cvt_pk_bf16_f32 v243, v246, v247
    v_fma_f32 v248, v248, v110, v111
    v_fma_f32 v249, v249, v110, v111
    v_fma_f32 v250, v250, v110, v111
    v_fma_f32 v251, v251, v110, v111
    v_fma_f32 v252, v252, v110, v111
    v_fma_f32 v253, v253, v110, v111
    ds_write_b128 v122, v[240:243] offset:4096
    v_fma_f32 v254, v254, v110, v111
    v_fma_f32 v255, v255, v110, v111
    v_cvt_pk_bf16_f32 v248, v248, v249
    v_cvt_pk_bf16_f32 v249, v250, v251
    v_cvt_pk_bf16_f32 v250, v252, v253
    v_cvt_pk_bf16_f32 v251, v254, v255
    ds_write_b128 v123, v[248:251] offset:4096
    ds_read2_b64 v[228:231], v124 offset0:0 offset1:16
    ds_read2_b64 v[236:239], v125 offset0:0 offset1:16
    ds_read2_b64 v[244:247], v126 offset0:0 offset1:16
    ds_read2_b64 v[252:255], v127 offset0:0 offset1:16
    s_waitcnt lgkmcnt(3)
    buffer_store_dwordx4 v[228:231], v9, s[48:51], s47 offen sc0 sc1 nt
    s_waitcnt lgkmcnt(2)
    buffer_store_dwordx4 v[236:239], v9, s[48:51], s47 offen offset:1024 sc0 sc1 nt
    s_waitcnt lgkmcnt(1)
    buffer_store_dwordx4 v[244:247], v9, s[48:51], s47 offen offset:2048 sc0 sc1 nt
    s_waitcnt lgkmcnt(0)
    buffer_store_dwordx4 v[252:255], v9, s[48:51], s47 offen offset:3072 sc0 sc1 nt
L_fin:
L_end:
    s_endpgm
L_var1:
    s_add_u32 s40, s18, s11
    s_addc_u32 s41, s19, 0
    s_add_u32 m0, s12, 0
    s_nop 0
    global_load_lds_dwordx4 v92, s[40:41]
    v_cmp_lt_i32 s[60:61], 0, v10
    v_cmp_lt_i32 s[62:63], 1, v10
    v_mfma_f32_32x32x16_bf16 v[128:143], a[212:215], a[212:215], 0
    v_cmp_lt_i32 s[64:65], 2, v10
    global_load_lds_dwordx4 v93, s[40:41] offset:1024
    v_cmp_lt_i32 s[66:67], 3, v10
    v_cmp_lt_i32 s[68:69], 16, v10
    v_mfma_f32_32x32x16_bf16 v[144:159], a[212:215], a[212:215], 0
    v_cmp_lt_i32 s[70:71], 17, v10
    global_load_lds_dwordx4 v94, s[40:41] offset:2048
    v_cmp_lt_i32 s[72:73], 18, v10
    v_cmp_lt_i32 s[74:75], 19, v10
    v_mfma_f32_32x32x16_bf16 v[160:175], a[212:215], a[212:215], 0
    global_load_lds_dwordx4 v95, s[40:41] offset:3072
    v_cmp_lt_i32 s[76:77], 32, v10
    v_cmp_lt_i32 s[78:79], 33, v10
    v_cmp_lt_i32 s[80:81], 34, v10
    v_mfma_f32_32x32x16_bf16 v[176:191], a[212:215], a[212:215], 0
    s_add_u32 s42, s20, s11
    s_addc_u32 s43, s21, 0
    s_add_u32 m0, s13, 0
    s_nop 0
    global_load_lds_dwordx4 v96, s[42:43]
    v_cmp_lt_i32 s[82:83], 35, v10
    v_cmp_lt_i32 s[84:85], 48, v10
    v_cmp_lt_i32 s[86:87], 49, v10
    v_mfma_f32_32x32x16_bf16 v[192:207], a[212:215], a[212:215], 0
    global_load_lds_dwordx4 v97, s[42:43] offset:1024
    v_cmp_lt_i32 s[88:89], 50, v10
    v_cmp_lt_i32 s[90:91], 51, v10
    v_lshrrev_b32 v1, 5, v2
    global_load_lds_dwordx4 v98, s[42:43] offset:2048
    v_mfma_f32_32x32x16_bf16 v[208:223], a[212:215], a[212:215], 0
    v_lshlrev_b32 v1, 4, v1
    v_lshrrev_b32 v1, v1, s32
    v_and_b32 v1, 0xffff, v1
    global_load_lds_dwordx4 v99, s[42:43] offset:3072
    v_mfma_f32_32x32x16_bf16 v[224:239], a[212:215], a[212:215], 0
    v_and_b32 v11, 1, v4
    v_lshlrev_b32 v11, 4, v11
    v_lshlrev_b32 v1, v11, v1
    s_add_u32 m0, s12, 16384
    s_add_u32 s14, s14, 0
    buffer_load_dwordx4 v5, s[36:39], s14 offen lds
    v_mfma_f32_32x32x16_bf16 v[240:255], a[212:215], a[212:215], 0
    v_and_b32 v11, 1, v3
    v_lshlrev_b32 v11, 1, v11
    buffer_load_dwordx4 v6, s[36:39], s14 offen offset:1024 lds
    v_lshrrev_b32 v12, 2, v4
    v_cmp_eq_u32 vcc, v11, v12
    v_add_u32 v11, 1, v11
    v_cmp_eq_u32 s[24:25], v11, v12
    buffer_load_dwordx4 v7, s[36:39], s14 offen offset:2048 lds
    v_cndmask_b32 v11, 0, v1, vcc
    s_nop 0
    v_cndmask_b32 v1, 0, v1, s[24:25]
    v_accvgpr_write_b32 a216, v11
    buffer_load_dwordx4 v8, s[36:39], s14 offen offset:3072 lds
    v_accvgpr_write_b32 a221, v11
    v_accvgpr_write_b32 a218, v1
    v_accvgpr_write_b32 a223, v1
    s_add_u32 m0, s12, 81920
    s_add_u32 s45, s14, 4096
    buffer_load_dwordx4 v5, s[36:39], s45 offen lds
    buffer_load_dwordx4 v6, s[36:39], s45 offen offset:1024 lds
    buffer_load_dwordx4 v7, s[36:39], s45 offen offset:2048 lds
    buffer_load_dwordx4 v8, s[36:39], s45 offen offset:3072 lds
    s_waitcnt vmcnt(16)
    s_barrier
    ds_read_b128 v[104:107], v80 offset:49152
    ds_read_b128 v[108:111], v81 offset:49152
    ds_read_b128 v[112:115], v82 offset:49152
    ds_read_b128 v[116:119], v83 offset:49152
    v_lshlrev_b32 v1, 1, v3
    v_xor_b32 v1, v4, v1
    v_lshlrev_b32 v1, 4, v1
    v_lshl_add_u32 v1, v3, 8, v1
    v_add_u32 v1, 114688, v1
    v_xor_b32 v11, 0x80, v1
    ds_read_b128 v[16:19], v1 offset:0
    ds_read_b128 v[20:23], v11 offset:1024
    ds_read_b128 v[24:27], v1 offset:2048
    ds_read_b128 v[28:31], v11 offset:3072
    v_sub_u32 v12, s6, v3
    v_mov_b32 v13, 0x7fff7fff
    v_cmp_lt_i32 vcc, 0, v12
    v_cvt_f32_u32 v14, s4
    s_nop 0
    v_cndmask_b32 v32, 0, v13, vcc
    v_cmp_lt_i32 vcc, 4, v12
    v_sqrt_f32 v14, v14
    s_nop 0
    v_cndmask_b32 v33, 0, v13, vcc
    v_cmp_lt_i32 vcc, 8, v12
    v_cmp_gt_u32 s[24:25], 32, v2
    s_nop 0
    v_cndmask_b32 v34, 0, v13, vcc
    v_cmp_lt_i32 vcc, 12, v12
    v_mul_f32 v14, 0x3ec00000, v14
    s_nop 0
    v_cndmask_b32 v35, 0, v13, vcc
    s_waitcnt lgkmcnt(0)
    v_and_b32 v16, v32, v16
    v_and_b32 v17, v32, v17
    v_and_b32 v18, v32, v18
    v_and_b32 v19, v32, v19
    v_and_b32 v20, v33, v20
    v_and_b32 v21, v33, v21
    v_and_b32 v22, v33, v22
    v_and_b32 v23, v33, v23
    v_and_b32 v24, v34, v24
    v_and_b32 v25, v34, v25
    v_and_b32 v26, v34, v26
    v_and_b32 v27, v34, v27
    v_and_b32 v28, v35, v28
    v_and_b32 v29, v35, v29
    v_and_b32 v30, v35, v30
    v_and_b32 v31, v35, v31
    v_pk_max_u16 v16, v16, v20
    v_pk_max_u16 v24, v24, v28
    v_pk_max_u16 v17, v17, v21
    v_pk_max_u16 v25, v25, v29
    v_pk_max_u16 v18, v18, v22
    v_pk_max_u16 v26, v26, v30
    v_pk_max_u16 v19, v19, v23
    v_pk_max_u16 v27, v27, v31
    v_pk_max_u16 v16, v16, v24
    v_pk_max_u16 v17, v17, v25
    v_pk_max_u16 v18, v18, v26
    v_pk_max_u16 v19, v19, v27
    v_pk_min_u16 v16, v16, v17
    v_pk_min_u16 v18, v18, v19
    v_pk_min_u16 v12, v16, v18
    v_lshlrev_b32 v13, 16, v12
    v_and_b32 v12, 0xffff0000, v12
    v_min_u32 v12, v12, v13
    s_nop 1
    v_min_u32_dpp v12, v12, v12 row_ror:8 row_mask:0xf bank_mask:0xf
    s_nop 1
    v_min_u32_dpp v12, v12, v12 row_ror:4 row_mask:0xf bank_mask:0xf
    s_nop 1
    v_min_u32_dpp v12, v12, v12 row_ror:2 row_mask:0xf bank_mask:0xf
    s_nop 1
    v_min_u32_dpp v12, v12, v12 row_ror:1 row_mask:0xf bank_mask:0xf
    v_mov_b32 v13, v12
    s_nop 1
    v_permlane32_swap_b32 v12, v13
    v_min_u32 v12, v12, v13
    v_mov_b32 v13, v12
    s_nop 1
    v_permlane16_swap_b32 v12, v13
    v_min_u32 v12, v12, v13
    v_cmp_gt_u32 vcc, 0x70000000, v12
    v_mul_f32 v12, v12, v14
    v_and_b32 v12, 0x7f800000, v12
    v_or_b32 v12, 0x400000, v12
    v_cndmask_b32 v12, 0, v12, vcc
    v_accvgpr_write_b32 a228, v12
    v_lshrrev_b32 v13, 16, v12
    v_cndmask_b32 v13, 0, v13, s[24:25]
    v_accvgpr_write_b32 a224, v13
    ds_read_b64_tr_b16 a[68:69], v84 offset:57344
    ds_read_b64_tr_b16 a[70:71], v84 offset:61440
    ds_read_b64_tr_b16 a[76:77], v85 offset:57344
    ds_read_b64_tr_b16 a[78:79], v85 offset:61440
    ds_read_b64_tr_b16 a[84:85], v86 offset:57344
    ds_read_b64_tr_b16 a[86:87], v86 offset:61440
    ds_read_b64_tr_b16 a[92:93], v87 offset:57344
    ds_read_b64_tr_b16 a[94:95], v87 offset:61440
    s_waitcnt lgkmcnt(2)
    ds_read_b64_tr_b16 a[100:101], v88 offset:57344
    ds_read_b64_tr_b16 a[102:103], v88 offset:61440
    ds_read_b64_tr_b16 a[108:109], v89 offset:57344
    ds_read_b64_tr_b16 a[110:111], v89 offset:61440
    ds_read_b64_tr_b16 a[116:117], v90 offset:57344
    ds_read_b64_tr_b16 a[118:119], v90 offset:61440
    ds_read_b64_tr_b16 a[124:125], v91 offset:57344
    ds_read_b64_tr_b16 a[126:127], v91 offset:61440
    ds_read_b64_tr_b16 a[64:65], v84 offset:49152
    ds_read_b64_tr_b16 a[66:67], v84 offset:53248
    ds_read_b64_tr_b16 a[72:73], v85 offset:49152
    ds_read_b64_tr_b16 a[74:75], v85 offset:53248
    ds_read_b64_tr_b16 a[80:81], v86 offset:49152
    ds_read_b64_tr_b16 a[82:83], v86 offset:53248
    ds_read_b64_tr_b16 a[88:89], v87 offset:49152
    ds_read_b64_tr_b16 a[90:91], v87 offset:53248
    s_waitcnt lgkmcnt(2)
    ds_read_b64_tr_b16 a[96:97], v88 offset:49152
    ds_read_b64_tr_b16 a[98:99], v88 offset:53248
    ds_read_b64_tr_b16 a[104:105], v89 offset:49152
    ds_read_b64_tr_b16 a[106:107], v89 offset:53248
    ds_read_b64_tr_b16 a[112:113], v90 offset:49152
    ds_read_b64_tr_b16 a[114:115], v90 offset:53248
    ds_read_b64_tr_b16 a[120:121], v91 offset:49152
    ds_read_b64_tr_b16 a[122:123], v91 offset:53248
    s_waitcnt vmcnt(8)
    s_barrier
    ds_read_b128 a[0:3], v80 offset:0
    ds_read_b128 a[4:7], v81 offset:0
    ds_read_b128 a[8:11], v82 offset:0
    ds_read_b128 a[12:15], v83 offset:0
    ds_read_b128 a[16:19], v80 offset:4096
    ds_read_b128 a[20:23], v81 offset:4096
    ds_read_b128 a[24:27], v82 offset:4096
    ds_read_b128 a[28:31], v83 offset:4096
    s_waitcnt lgkmcnt(2)
    ds_read_b128 a[32:35], v80 offset:8192
    ds_read_b128 a[36:39], v81 offset:8192
    ds_read_b128 a[40:43], v82 offset:8192
    ds_read_b128 a[44:47], v83 offset:8192
    ds_read_b128 a[48:51], v80 offset:12288
    ds_read_b128 a[52:55], v81 offset:12288
    ds_read_b128 a[56:59], v82 offset:12288
    ds_read_b128 a[60:63], v83 offset:12288
    s_add_u32 m0, s12, 32768
    s_add_u32 s46, s14, 8192
    buffer_load_dwordx4 v5, s[36:39], s46 offen lds
    buffer_load_dwordx4 v6, s[36:39], s46 offen offset:1024 lds
    buffer_load_dwordx4 v7, s[36:39], s46 offen offset:2048 lds
    buffer_load_dwordx4 v8, s[36:39], s46 offen offset:3072 lds
    s_waitcnt vmcnt(8)
    ds_read_b128 v[16:19], v120 offset:16384
    ds_read_b128 v[20:23], v120 offset:16384
    ds_read_b128 v[24:27], v121 offset:16384
    ds_read_b128 v[28:31], v121 offset:16384
    ds_read_b128 v[32:35], v122 offset:16384
    ds_read_b128 v[36:39], v122 offset:16384
    ds_read_b128 v[40:43], v123 offset:16384
    ds_read_b128 v[44:47], v123 offset:16384
    s_waitcnt lgkmcnt(6)
    v_smfmac_f32_16x16x64_bf16 v[128:131], a[216:219], v[16:23], v0
    s_add_u32 m0, s12, 98304
    s_add_u32 s47, s14, 12288
    buffer_load_dwordx4 v5, s[36:39], s47 offen lds
    v_smfmac_f32_16x16x64_bf16 v[132:135], a[220:223], v[16:23], v0
    s_waitcnt vmcnt(5)
    ds_read_b128 v[16:19], v124 offset:16384
    ds_read_b128 v[20:23], v124 offset:16384
    s_waitcnt lgkmcnt(6)
    v_smfmac_f32_16x16x64_bf16 v[136:139], a[216:219], v[24:31], v0
    s_nop 4
    v_cvt_pk_bf16_f32 v128, v128, v129
    v_cvt_pk_bf16_f32 v129, v130, v131
    v_accvgpr_write_b32 a128, v128
    v_accvgpr_write_b32 a129, v129
    v_smfmac_f32_16x16x64_bf16 v[140:143], a[220:223], v[24:31], v0
    ds_read_b128 v[24:27], v125 offset:16384
    ds_read_b128 v[28:31], v125 offset:16384
    v_cvt_pk_bf16_f32 v132, v132, v133
    v_cvt_pk_bf16_f32 v133, v134, v135
    v_accvgpr_write_b32 a130, v132
    v_accvgpr_write_b32 a131, v133
    s_waitcnt lgkmcnt(6)
    v_smfmac_f32_16x16x64_bf16 v[144:147], a[216:219], v[32:39], v0
    buffer_load_dwordx4 v6, s[36:39], s47 offen offset:1024 lds
    v_cvt_pk_bf16_f32 v136, v136, v137
    v_cvt_pk_bf16_f32 v137, v138, v139
    v_accvgpr_write_b32 a132, v136
    v_accvgpr_write_b32 a133, v137
    v_smfmac_f32_16x16x64_bf16 v[148:151], a[220:223], v[32:39], v0
    ds_read_b128 v[32:35], v126 offset:16384
    ds_read_b128 v[36:39], v126 offset:16384
    v_cvt_pk_bf16_f32 v140, v140, v141
    v_cvt_pk_bf16_f32 v141, v142, v143
    v_accvgpr_write_b32 a134, v140
    v_accvgpr_write_b32 a135, v141
    s_waitcnt lgkmcnt(6)
    v_smfmac_f32_16x16x64_bf16 v[152:155], a[216:219], v[40:47], v0
    v_cvt_pk_bf16_f32 v144, v144, v145
    v_cvt_pk_bf16_f32 v145, v146, v147
    v_accvgpr_write_b32 a136, v144
    v_accvgpr_write_b32 a137, v145
    v_smfmac_f32_16x16x64_bf16 v[156:159], a[220:223], v[40:47], v0
    ds_read_b128 v[40:43], v127 offset:16384
    ds_read_b128 v[44:47], v127 offset:16384
    v_cvt_pk_bf16_f32 v148, v148, v149
    v_cvt_pk_bf16_f32 v149, v150, v151
    v_accvgpr_write_b32 a138, v148
    v_accvgpr_write_b32 a139, v149
    s_waitcnt lgkmcnt(6)
    v_smfmac_f32_16x16x64_bf16 v[160:163], a[216:219], v[16:23], v0
    buffer_load_dwordx4 v7, s[36:39], s47 offen offset:2048 lds
    v_cvt_pk_bf16_f32 v152, v152, v153
    v_cvt_pk_bf16_f32 v153, v154, v155
    v_accvgpr_write_b32 a140, v152
    v_accvgpr_write_b32 a141, v153
    v_smfmac_f32_16x16x64_bf16 v[164:167], a[220:223], v[16:23], v0
    v_cvt_pk_bf16_f32 v156, v156, v157
    v_cvt_pk_bf16_f32 v157, v158, v159
    v_accvgpr_write_b32 a142, v156
    v_accvgpr_write_b32 a143, v157
    s_waitcnt lgkmcnt(4)
    v_smfmac_f32_16x16x64_bf16 v[168:171], a[216:219], v[24:31], v0
    v_cvt_pk_bf16_f32 v160, v160, v161
    v_cvt_pk_bf16_f32 v161, v162, v163
    v_accvgpr_write_b32 a144, v160
    v_accvgpr_write_b32 a145, v161
    v_smfmac_f32_16x16x64_bf16 v[172:175], a[220:223], v[24:31], v0
    v_cvt_pk_bf16_f32 v164, v164, v165
    v_cvt_pk_bf16_f32 v165, v166, v167
    v_accvgpr_write_b32 a146, v164
    v_accvgpr_write_b32 a147, v165
    s_waitcnt lgkmcnt(2)
    v_smfmac_f32_16x16x64_bf16 v[176:179], a[216:219], v[32:39], v0
    buffer_load_dwordx4 v8, s[36:39], s47 offen offset:3072 lds
    v_cvt_pk_bf16_f32 v168, v168, v169
    v_cvt_pk_bf16_f32 v169, v170, v171
    v_accvgpr_write_b32 a148, v168
    v_accvgpr_write_b32 a149, v169
    v_smfmac_f32_16x16x64_bf16 v[180:183], a[220:223], v[32:39], v0
    v_cvt_pk_bf16_f32 v172, v172, v173
    v_cvt_pk_bf16_f32 v173, v174, v175
    v_accvgpr_write_b32 a150, v172
    v_accvgpr_write_b32 a151, v173
    s_waitcnt lgkmcnt(0)
    v_smfmac_f32_16x16x64_bf16 v[184:187], a[216:219], v[40:47], v0
    v_cvt_pk_bf16_f32 v176, v176, v177
    v_cvt_pk_bf16_f32 v177, v178, v179
    v_accvgpr_write_b32 a152, v176
    v_accvgpr_write_b32 a153, v177
    v_smfmac_f32_16x16x64_bf16 v[188:191], a[220:223], v[40:47], v0
    v_cvt_pk_bf16_f32 v180, v180, v181
    v_cvt_pk_bf16_f32 v181, v182, v183
    v_accvgpr_write_b32 a154, v180
    v_accvgpr_write_b32 a155, v181
    s_nop 2
    v_cvt_pk_bf16_f32 v184, v184, v185
    v_cvt_pk_bf16_f32 v185, v186, v187
    v_accvgpr_write_b32 a156, v184
    v_accvgpr_write_b32 a157, v185
    v_cvt_pk_bf16_f32 v188, v188, v189
    v_cvt_pk_bf16_f32 v189, v190, v191
    v_accvgpr_write_b32 a158, v188
    v_accvgpr_write_b32 a159, v189
    s_waitcnt lgkmcnt(0)
    s_nop 0
    v_mfma_f32_16x16x32_bf16 v[16:19], v[104:107], a[128:131], 0
    v_mfma_f32_16x16x32_bf16 v[16:19], v[108:111], a[132:135], v[16:19]
    v_mfma_f32_16x16x32_bf16 v[16:19], v[112:115], a[136:139], v[16:19]
    v_mfma_f32_16x16x32_bf16 v[16:19], v[116:119], a[140:143], v[16:19]
    v_mfma_f32_16x16x32_bf16 v[32:35], v[104:107], a[144:147], 0
    v_mfma_f32_16x16x32_bf16 v[32:35], v[108:111], a[148:151], v[32:35]
    v_mfma_f32_16x16x32_bf16 v[32:35], v[112:115], a[152:155], v[32:35]
    v_mfma_f32_16x16x32_bf16 v[32:35], v[116:119], a[156:159], v[32:35]
    s_nop 3
    v_cndmask_b32 v16, v102, v16, s[60:61]
    v_cndmask_b32 v17, v102, v17, s[62:63]
    v_cndmask_b32 v18, v102, v18, s[64:65]
    v_cndmask_b32 v19, v102, v19, s[66:67]
    v_max3_f32 v12, v16, v17, v18
    v_max_f32 v12, v12, v19
    v_cndmask_b32 v32, v102, v32, s[60:61]
    v_cndmask_b32 v33, v102, v33, s[62:63]
    v_cndmask_b32 v34, v102, v34, s[64:65]
    v_cndmask_b32 v35, v102, v35, s[66:67]
    v_max3_f32 v14, v32, v33, v34
    v_max_f32 v14, v14, v35
    s_cmp_gt_u32 s6, 16
    s_cbranch_scc1 L_fa01_1_more
L_fa01_1:
    v_mov_b32 v13, v12
    v_mov_b32 v15, v14
    v_mfma_f32_32x32x16_bf16 v[128:143], a[208:211], a[224:227], 0
    v_permlane32_swap_b32 v12, v13
    v_permlane32_swap_b32 v14, v15
    v_max_f32 v12, v12, v13
    v_max_f32 v14, v14, v15
    v_mov_b32 v13, v12
    v_mov_b32 v15, v14
    v_mfma_f32_32x32x16_bf16 v[144:159], a[208:211], a[224:227], 0
    v_permlane16_swap_b32 v12, v13
    v_permlane16_swap_b32 v14, v15
    v_max_f32 v12, v12, v13
    v_max_f32 v14, v14, v15
    v_add_f32 v12, 0x40800000, v12
    v_add_f32 v14, 0x40800000, v14
    v_sub_f32 v64, 0, v12
    v_sub_f32 v65, 0, v12
    v_sub_f32 v66, 0, v12
    v_sub_f32 v67, 0, v12
    v_mfma_f32_32x32x16_bf16 v[160:175], a[208:211], a[224:227], 0
    v_sub_f32 v68, 0, v14
    v_sub_f32 v69, 0, v14
    v_sub_f32 v70, 0, v14
    v_sub_f32 v71, 0, v14
    v_mfma_f32_32x32x16_bf16 v[176:191], a[208:211], a[224:227], 0
    v_sub_f32 v16, v16, v12
    v_sub_f32 v17, v17, v12
    v_sub_f32 v18, v18, v12
    v_sub_f32 v19, v19, v12
    v_exp_f32 v16, v16
    v_exp_f32 v17, v17
    v_exp_f32 v18, v18
    v_exp_f32 v19, v19
    v_sub_f32 v32, v32, v14
    v_sub_f32 v33, v33, v14
    v_sub_f32 v34, v34, v14
    v_sub_f32 v35, v35, v14
    v_exp_f32 v32, v32
    v_exp_f32 v33, v33
    v_exp_f32 v34, v34
    v_exp_f32 v35, v35
    v_cvt_pk_bf16_f32 v48, v16, v17
    v_cvt_pk_bf16_f32 v49, v18, v19
    v_cvt_pk_bf16_f32 v56, v32, v33
    v_cvt_pk_bf16_f32 v57, v34, v35
    s_cmp_gt_u32 s6, 16
    s_cbranch_scc1 L_fb01_1_more
L_fb01_1:
    s_waitcnt lgkmcnt(0)
    s_nop 0
    v_smfmac_f32_16x16x64_bf16 a[192:195], a[208:211], v[48:55], v101
    v_mfma_f32_16x16x32_bf16 v[128:131], a[64:67], v[48:51], v[128:131]
    s_add_u32 s40, s18, s44
    s_addc_u32 s41, s19, 0
    s_add_u32 m0, s12, 16384
    s_nop 0
    global_load_lds_dwordx4 v92, s[40:41]
    v_mfma_f32_16x16x32_bf16 v[132:135], a[72:75], v[48:51], v[132:135]
    v_mfma_f32_16x16x32_bf16 v[136:139], a[80:83], v[48:51], v[136:139]
    global_load_lds_dwordx4 v93, s[40:41] offset:1024
    v_mfma_f32_16x16x32_bf16 v[140:143], a[88:91], v[48:51], v[140:143]
    v_mfma_f32_16x16x32_bf16 v[144:147], a[96:99], v[48:51], v[144:147]
    global_load_lds_dwordx4 v94, s[40:41] offset:2048
    v_mfma_f32_16x16x32_bf16 v[148:151], a[104:107], v[48:51], v[148:151]
    v_mfma_f32_16x16x32_bf16 v[152:155], a[112:115], v[48:51], v[152:155]
    global_load_lds_dwordx4 v95, s[40:41] offset:3072
    v_mfma_f32_16x16x32_bf16 v[156:159], a[120:123], v[48:51], v[156:159]
    v_smfmac_f32_16x16x64_bf16 a[196:199], a[208:211], v[56:63], v101
    s_add_u32 s42, s20, s44
    s_addc_u32 s43, s21, 0
    s_add_u32 m0, s13, 16384
    s_nop 0
    global_load_lds_dwordx4 v96, s[42:43]
    v_mfma_f32_16x16x32_bf16 v[160:163], a[64:67], v[56:59], v[160:163]
    v_mfma_f32_16x16x32_bf16 v[164:167], a[72:75], v[56:59], v[164:167]
    global_load_lds_dwordx4 v97, s[42:43] offset:1024
    v_mfma_f32_16x16x32_bf16 v[168:171], a[80:83], v[56:59], v[168:171]
    v_mfma_f32_16x16x32_bf16 v[172:175], a[88:91], v[56:59], v[172:175]
    global_load_lds_dwordx4 v98, s[42:43] offset:2048
    v_mfma_f32_16x16x32_bf16 v[176:179], a[96:99], v[56:59], v[176:179]
    v_mfma_f32_16x16x32_bf16 v[180:183], a[104:107], v[56:59], v[180:183]
    global_load_lds_dwordx4 v99, s[42:43] offset:3072
    v_mfma_f32_16x16x32_bf16 v[184:187], a[112:115], v[56:59], v[184:187]
    v_mfma_f32_16x16x32_bf16 v[188:191], a[120:123], v[56:59], v[188:191]
    s_cmp_gt_u32 s6, 32
    s_cbranch_scc1 L_fc01_1_more
L_fc01_1:
    s_waitcnt vmcnt(12)
    ds_read_b128 v[16:19], v120 offset:32768
    ds_read_b128 v[20:23], v120 offset:32768
    ds_read_b128 v[24:27], v121 offset:32768
    ds_read_b128 v[28:31], v121 offset:32768
    ds_read_b128 v[32:35], v122 offset:32768
    ds_read_b128 v[36:39], v122 offset:32768
    ds_read_b128 v[40:43], v123 offset:32768
    ds_read_b128 v[44:47], v123 offset:32768
    s_waitcnt lgkmcnt(6)
    v_smfmac_f32_16x16x64_bf16 v[192:195], a[216:219], v[16:23], v0
    v_smfmac_f32_16x16x64_bf16 v[196:199], a[220:223], v[16:23], v0
    s_waitcnt vmcnt(8)
    ds_read_b128 v[16:19], v124 offset:32768
    ds_read_b128 v[20:23], v124 offset:32768
    s_waitcnt lgkmcnt(6)
    v_smfmac_f32_16x16x64_bf16 v[200:203], a[216:219], v[24:31], v0
    s_nop 4
    v_cvt_pk_bf16_f32 v192, v192, v193
    v_cvt_pk_bf16_f32 v193, v194, v195
    v_accvgpr_write_b32 a160, v192
    v_accvgpr_write_b32 a161, v193
    v_smfmac_f32_16x16x64_bf16 v[204:207], a[220:223], v[24:31], v0
    ds_read_b128 v[24:27], v125 offset:32768
    ds_read_b128 v[28:31], v125 offset:32768
    v_cvt_pk_bf16_f32 v196, v196, v197
    v_cvt_pk_bf16_f32 v197, v198, v199
    v_accvgpr_write_b32 a162, v196
    v_accvgpr_write_b32 a163, v197
    s_waitcnt lgkmcnt(6)
    v_smfmac_f32_16x16x64_bf16 v[208:211], a[216:219], v[32:39], v0
    v_cvt_pk_bf16_f32 v200, v200, v201
    v_cvt_pk_bf16_f32 v201, v202, v203
    v_accvgpr_write_b32 a164, v200
    v_accvgpr_write_b32 a165, v201
    v_smfmac_f32_16x16x64_bf16 v[212:215], a[220:223], v[32:39], v0
    ds_read_b128 v[32:35], v126 offset:32768
    ds_read_b128 v[36:39], v126 offset:32768
    v_cvt_pk_bf16_f32 v204, v204, v205
    v_cvt_pk_bf16_f32 v205, v206, v207
    v_accvgpr_write_b32 a166, v204
    v_accvgpr_write_b32 a167, v205
    s_waitcnt lgkmcnt(6)
    v_smfmac_f32_16x16x64_bf16 v[216:219], a[216:219], v[40:47], v0
    v_cvt_pk_bf16_f32 v208, v208, v209
    v_cvt_pk_bf16_f32 v209, v210, v211
    v_accvgpr_write_b32 a168, v208
    v_accvgpr_write_b32 a169, v209
    v_smfmac_f32_16x16x64_bf16 v[220:223], a[220:223], v[40:47], v0
    ds_read_b128 v[40:43], v127 offset:32768
    ds_read_b128 v[44:47], v127 offset:32768
    v_cvt_pk_bf16_f32 v212, v212, v213
    v_cvt_pk_bf16_f32 v213, v214, v215
    v_accvgpr_write_b32 a170, v212
    v_accvgpr_write_b32 a171, v213
    s_waitcnt lgkmcnt(6)
    v_smfmac_f32_16x16x64_bf16 v[224:227], a[216:219], v[16:23], v0
    v_cvt_pk_bf16_f32 v216, v216, v217
    v_cvt_pk_bf16_f32 v217, v218, v219
    v_accvgpr_write_b32 a172, v216
    v_accvgpr_write_b32 a173, v217
    v_smfmac_f32_16x16x64_bf16 v[228:231], a[220:223], v[16:23], v0
    v_cvt_pk_bf16_f32 v220, v220, v221
    v_cvt_pk_bf16_f32 v221, v222, v223
    v_accvgpr_write_b32 a174, v220
    v_accvgpr_write_b32 a175, v221
    s_waitcnt lgkmcnt(4)
    v_smfmac_f32_16x16x64_bf16 v[232:235], a[216:219], v[24:31], v0
    v_cvt_pk_bf16_f32 v224, v224, v225
    v_cvt_pk_bf16_f32 v225, v226, v227
    v_accvgpr_write_b32 a176, v224
    v_accvgpr_write_b32 a177, v225
    v_smfmac_f32_16x16x64_bf16 v[236:239], a[220:223], v[24:31], v0
    v_cvt_pk_bf16_f32 v228, v228, v229
    v_cvt_pk_bf16_f32 v229, v230, v231
    v_accvgpr_write_b32 a178, v228
    v_accvgpr_write_b32 a179, v229
    s_waitcnt lgkmcnt(2)
    v_smfmac_f32_16x16x64_bf16 v[240:243], a[216:219], v[32:39], v0
    v_cvt_pk_bf16_f32 v232, v232, v233
    v_cvt_pk_bf16_f32 v233, v234, v235
    v_accvgpr_write_b32 a180, v232
    v_accvgpr_write_b32 a181, v233
    v_smfmac_f32_16x16x64_bf16 v[244:247], a[220:223], v[32:39], v0
    v_cvt_pk_bf16_f32 v236, v236, v237
    v_cvt_pk_bf16_f32 v237, v238, v239
    v_accvgpr_write_b32 a182, v236
    v_accvgpr_write_b32 a183, v237
    s_waitcnt lgkmcnt(0)
    v_smfmac_f32_16x16x64_bf16 v[248:251], a[216:219], v[40:47], v0
    v_cvt_pk_bf16_f32 v240, v240, v241
    v_cvt_pk_bf16_f32 v241, v242, v243
    v_accvgpr_write_b32 a184, v240
    v_accvgpr_write_b32 a185, v241
    v_smfmac_f32_16x16x64_bf16 v[252:255], a[220:223], v[40:47], v0
    v_cvt_pk_bf16_f32 v244, v244, v245
    v_cvt_pk_bf16_f32 v245, v246, v247
    v_accvgpr_write_b32 a186, v244
    v_accvgpr_write_b32 a187, v245
    s_nop 2
    v_cvt_pk_bf16_f32 v248, v248, v249
    v_cvt_pk_bf16_f32 v249, v250, v251
    v_accvgpr_write_b32 a188, v248
    v_accvgpr_write_b32 a189, v249
    v_cvt_pk_bf16_f32 v252, v252, v253
    v_cvt_pk_bf16_f32 v253, v254, v255
    v_accvgpr_write_b32 a190, v252
    v_accvgpr_write_b32 a191, v253
    v_mov_b32 v44, v102
    v_mov_b32 v45, v102
    v_mov_b32 v46, v102
    v_mov_b32 v47, v102
    s_waitcnt lgkmcnt(0)
    s_nop 0
    v_mfma_f32_16x16x32_bf16 v[16:19], v[104:107], a[160:163], 0
    v_mfma_f32_16x16x32_bf16 v[16:19], v[108:111], a[164:167], v[16:19]
    v_mfma_f32_16x16x32_bf16 v[16:19], v[112:115], a[168:171], v[16:19]
    v_mfma_f32_16x16x32_bf16 v[16:19], v[116:119], a[172:175], v[16:19]
    v_mfma_f32_16x16x32_bf16 v[32:35], v[104:107], a[176:179], 0
    v_mfma_f32_16x16x32_bf16 v[32:35], v[108:111], a[180:183], v[32:35]
    v_mfma_f32_16x16x32_bf16 v[32:35], v[112:115], a[184:187], v[32:35]
    v_mfma_f32_16x16x32_bf16 v[32:35], v[116:119], a[188:191], v[32:35]
    s_nop 3
    v_cndmask_b32 v16, v102, v16, s[60:61]
    v_cndmask_b32 v17, v102, v17, s[62:63]
    v_cndmask_b32 v18, v102, v18, s[64:65]
    v_cndmask_b32 v19, v102, v19, s[66:67]
    v_max3_f32 v12, v16, v17, v18
    v_max_f32 v12, v12, v19
    v_cndmask_b32 v32, v102, v32, s[60:61]
    v_cndmask_b32 v33, v102, v33, s[62:63]
    v_cndmask_b32 v34, v102, v34, s[64:65]
    v_cndmask_b32 v35, v102, v35, s[66:67]
    v_max3_f32 v14, v32, v33, v34
    v_max_f32 v14, v14, v35
    s_cmp_gt_u32 s6, 16
    s_cbranch_scc1 L_fa23_1_more
L_fa23_1:
    v_mov_b32 v13, v12
    v_mov_b32 v15, v14
    v_mfma_f32_32x32x16_bf16 v[192:207], a[208:211], a[224:227], 0
    v_permlane32_swap_b32 v12, v13
    v_permlane32_swap_b32 v14, v15
    v_max_f32 v12, v12, v13
    v_max_f32 v14, v14, v15
    v_mov_b32 v13, v12
    v_mov_b32 v15, v14
    v_mfma_f32_32x32x16_bf16 v[208:223], a[208:211], a[224:227], 0
    v_permlane16_swap_b32 v12, v13
    v_permlane16_swap_b32 v14, v15
    v_max_f32 v12, v12, v13
    v_max_f32 v14, v14, v15
    v_add_f32 v12, 0x40800000, v12
    v_add_f32 v14, 0x40800000, v14
    v_sub_f32 v72, 0, v12
    v_sub_f32 v73, 0, v12
    v_sub_f32 v74, 0, v12
    v_sub_f32 v75, 0, v12
    v_mfma_f32_32x32x16_bf16 v[224:239], a[208:211], a[224:227], 0
    v_sub_f32 v76, 0, v14
    v_sub_f32 v77, 0, v14
    v_sub_f32 v78, 0, v14
    v_sub_f32 v79, 0, v14
    v_mfma_f32_32x32x16_bf16 v[240:255], a[208:211], a[224:227], 0
    v_sub_f32 v16, v16, v12
    v_sub_f32 v17, v17, v12
    v_sub_f32 v18, v18, v12
    v_sub_f32 v19, v19, v12
    v_exp_f32 v16, v16
    v_exp_f32 v17, v17
    v_exp_f32 v18, v18
    v_exp_f32 v19, v19
    v_sub_f32 v32, v32, v14
    v_sub_f32 v33, v33, v14
    v_sub_f32 v34, v34, v14
    v_sub_f32 v35, v35, v14
    v_exp_f32 v32, v32
    v_exp_f32 v33, v33
    v_exp_f32 v34, v34
    v_exp_f32 v35, v35
    v_cvt_pk_bf16_f32 v48, v16, v17
    v_cvt_pk_bf16_f32 v49, v18, v19
    v_cvt_pk_bf16_f32 v56, v32, v33
    v_cvt_pk_bf16_f32 v57, v34, v35
    s_cmp_gt_u32 s6, 16
    s_cbranch_scc1 L_fb23_1_more
L_fb23_1:
    s_waitcnt lgkmcnt(0)
    s_nop 0
    v_smfmac_f32_16x16x64_bf16 a[200:203], a[208:211], v[48:55], v101
    v_mfma_f32_16x16x32_bf16 v[192:195], a[64:67], v[48:51], v[192:195]
    s_add_u32 s40, s18, s10
    s_addc_u32 s41, s19, 0
    s_add_u32 m0, s12, 32768
    s_nop 0
    global_load_lds_dwordx4 v92, s[40:41]
    v_mfma_f32_16x16x32_bf16 v[196:199], a[72:75], v[48:51], v[196:199]
    v_mfma_f32_16x16x32_bf16 v[200:203], a[80:83], v[48:51], v[200:203]
    global_load_lds_dwordx4 v93, s[40:41] offset:1024
    v_mfma_f32_16x16x32_bf16 v[204:207], a[88:91], v[48:51], v[204:207]
    v_mfma_f32_16x16x32_bf16 v[208:211], a[96:99], v[48:51], v[208:211]
    global_load_lds_dwordx4 v94, s[40:41] offset:2048
    v_mfma_f32_16x16x32_bf16 v[212:215], a[104:107], v[48:51], v[212:215]
    v_mfma_f32_16x16x32_bf16 v[216:219], a[112:115], v[48:51], v[216:219]
    global_load_lds_dwordx4 v95, s[40:41] offset:3072
    v_mfma_f32_16x16x32_bf16 v[220:223], a[120:123], v[48:51], v[220:223]
    s_cmp_gt_u32 s6, 32
    s_cbranch_scc1 L_fc2_1_more
L_fc2_1:
    s_add_u32 s42, s20, s10
    s_addc_u32 s43, s21, 0
    s_branch L_join
L_code_end:
L_fa01_1_more:
    ds_read_b128 v[104:107], v80 offset:53248
    ds_read_b128 v[108:111], v81 offset:53248
    ds_read_b128 v[112:115], v82 offset:53248
    ds_read_b128 v[116:119], v83 offset:53248
    s_waitcnt lgkmcnt(0)
    v_mfma_f32_16x16x32_bf16 v[20:23], v[104:107], a[128:131], 0
    v_mfma_f32_16x16x32_bf16 v[20:23], v[108:111], a[132:135], v[20:23]
    v_mfma_f32_16x16x32_bf16 v[20:23], v[112:115], a[136:139], v[20:23]
    v_mfma_f32_16x16x32_bf16 v[20:23], v[116:119], a[140:143], v[20:23]
    v_mfma_f32_16x16x32_bf16 v[36:39], v[104:107], a[144:147], 0
    v_mfma_f32_16x16x32_bf16 v[36:39], v[108:111], a[148:151], v[36:39]
    v_mfma_f32_16x16x32_bf16 v[36:39], v[112:115], a[152:155], v[36:39]
    v_mfma_f32_16x16x32_bf16 v[36:39], v[116:119], a[156:159], v[36:39]
    s_nop 3
    v_cndmask_b32 v20, v102, v20, s[68:69]
    v_cndmask_b32 v21, v102, v21, s[70:71]
    v_cndmask_b32 v22, v102, v22, s[72:73]
    v_cndmask_b32 v23, v102, v23, s[74:75]
    v_max3_f32 v12, v12, v20, v21
    v_max3_f32 v12, v12, v22, v23
    v_cndmask_b32 v36, v102, v36, s[68:69]
    v_cndmask_b32 v37, v102, v37, s[70:71]
    v_cndmask_b32 v38, v102, v38, s[72:73]
    v_cndmask_b32 v39, v102, v39, s[74:75]
    v_max3_f32 v14, v14, v36, v37
    v_max3_f32 v14, v14, v38, v39
    s_cmp_le_u32 s6, 32
    s_cbranch_scc1 L_fa01_1_r
    ds_read_b128 v[104:107], v80 offset:57344
    ds_read_b128 v[108:111], v81 offset:57344
    ds_read_b128 v[112:115], v82 offset:57344
    ds_read_b128 v[116:119], v83 offset:57344
    s_waitcnt lgkmcnt(0)
    v_mfma_f32_16x16x32_bf16 v[24:27], v[104:107], a[128:131], 0
    v_mfma_f32_16x16x32_bf16 v[24:27], v[108:111], a[132:135], v[24:27]
    v_mfma_f32_16x16x32_bf16 v[24:27], v[112:115], a[136:139], v[24:27]
    v_mfma_f32_16x16x32_bf16 v[24:27], v[116:119], a[140:143], v[24:27]
    v_mfma_f32_16x16x32_bf16 v[40:43], v[104:107], a[144:147], 0
    v_mfma_f32_16x16x32_bf16 v[40:43], v[108:111], a[148:151], v[40:43]
    v_mfma_f32_16x16x32_bf16 v[40:43], v[112:115], a[152:155], v[40:43]
    v_mfma_f32_16x16x32_bf16 v[40:43], v[116:119], a[156:159], v[40:43]
    s_nop 3
    v_cndmask_b32 v24, v102, v24, s[76:77]
    v_cndmask_b32 v25, v102, v25, s[78:79]
    v_cndmask_b32 v26, v102, v26, s[80:81]
    v_cndmask_b32 v27, v102, v27, s[82:83]
    v_max3_f32 v12, v12, v24, v25
    v_max3_f32 v12, v12, v26, v27
    v_cndmask_b32 v40, v102, v40, s[76:77]
    v_cndmask_b32 v41, v102, v41, s[78:79]
    v_cndmask_b32 v42, v102, v42, s[80:81]
    v_cndmask_b32 v43, v102, v43, s[82:83]
    v_max3_f32 v14, v14, v40, v41
    v_max3_f32 v14, v14, v42, v43
    s_cmp_le_u32 s6, 48
    s_cbranch_scc1 L_fa01_1_r
    ds_read_b128 v[104:107], v80 offset:61440
    ds_read_b128 v[108:111], v81 offset:61440
    ds_read_b128 v[112:115], v82 offset:61440
    ds_read_b128 v[116:119], v83 offset:61440
    s_waitcnt lgkmcnt(0)
    v_mfma_f32_16x16x32_bf16 v[28:31], v[104:107], a[128:131], 0
    v_mfma_f32_16x16x32_bf16 v[28:31], v[108:111], a[132:135], v[28:31]
    v_mfma_f32_16x16x32_bf16 v[28:31], v[112:115], a[136:139], v[28:31]
    v_mfma_f32_16x16x32_bf16 v[28:31], v[116:119], a[140:143], v[28:31]
    v_mfma_f32_16x16x32_bf16 v[44:47], v[104:107], a[144:147], 0
    v_mfma_f32_16x16x32_bf16 v[44:47], v[108:111], a[148:151], v[44:47]
    v_mfma_f32_16x16x32_bf16 v[44:47], v[112:115], a[152:155], v[44:47]
    v_mfma_f32_16x16x32_bf16 v[44:47], v[116:119], a[156:159], v[44:47]
    s_nop 3
    v_cndmask_b32 v28, v102, v28, s[84:85]
    v_cndmask_b32 v29, v102, v29, s[86:87]
    v_cndmask_b32 v30, v102, v30, s[88:89]
    v_cndmask_b32 v31, v102, v31, s[90:91]
    v_max3_f32 v12, v12, v28, v29
    v_max3_f32 v12, v12, v30, v31
    v_cndmask_b32 v44, v102, v44, s[84:85]
    v_cndmask_b32 v45, v102, v45, s[86:87]
    v_cndmask_b32 v46, v102, v46, s[88:89]
    v_cndmask_b32 v47, v102, v47, s[90:91]
    v_max3_f32 v14, v14, v44, v45
    v_max3_f32 v14, v14, v46, v47
L_fa01_1_r:
    ds_read_b128 v[104:107], v80 offset:49152
    ds_read_b128 v[108:111], v81 offset:49152
    ds_read_b128 v[112:115], v82 offset:49152
    ds_read_b128 v[116:119], v83 offset:49152
    s_branch L_fa01_1
L_fb01_1_more:
    v_sub_f32 v20, v20, v12
    v_sub_f32 v21, v21, v12
    v_sub_f32 v22, v22, v12
    v_sub_f32 v23, v23, v12
    v_exp_f32 v20, v20
    v_exp_f32 v21, v21
    v_exp_f32 v22, v22
    v_exp_f32 v23, v23
    v_sub_f32 v36, v36, v14
    v_sub_f32 v37, v37, v14
    v_sub_f32 v38, v38, v14
    v_sub_f32 v39, v39, v14
    v_exp_f32 v36, v36
    v_exp_f32 v37, v37
    v_exp_f32 v38, v38
    v_exp_f32 v39, v39
    v_cvt_pk_bf16_f32 v50, v20, v21
    v_cvt_pk_bf16_f32 v51, v22, v23
    v_cvt_pk_bf16_f32 v58, v36, v37
    v_cvt_pk_bf16_f32 v59, v38, v39
    s_cmp_le_u32 s6, 32
    s_cbranch_scc1 L_fb01_1
    v_sub_f32 v24, v24, v12
    v_sub_f32 v25, v25, v12
    v_sub_f32 v26, v26, v12
    v_sub_f32 v27, v27, v12
    v_exp_f32 v24, v24
    v_exp_f32 v25, v25
    v_exp_f32 v26, v26
    v_exp_f32 v27, v27
    v_sub_f32 v40, v40, v14
    v_sub_f32 v41, v41, v14
    v_sub_f32 v42, v42, v14
    v_sub_f32 v43, v43, v14
    v_exp_f32 v40, v40
    v_exp_f32 v41, v41
    v_exp_f32 v42, v42
    v_exp_f32 v43, v43
    v_cvt_pk_bf16_f32 v52, v24, v25
    v_cvt_pk_bf16_f32 v53, v26, v27
    v_cvt_pk_bf16_f32 v60, v40, v41
    v_cvt_pk_bf16_f32 v61, v42, v43
    s_cmp_le_u32 s6, 48
    s_cbranch_scc1 L_fb01_1
    v_sub_f32 v28, v28, v12
    v_sub_f32 v29, v29, v12
    v_sub_f32 v30, v30, v12
    v_sub_f32 v31, v31, v12
    v_exp_f32 v28, v28
    v_exp_f32 v29, v29
    v_exp_f32 v30, v30
    v_exp_f32 v31, v31
    v_sub_f32 v44, v44, v14
    v_sub_f32 v45, v45, v14
    v_sub_f32 v46, v46, v14
    v_sub_f32 v47, v47, v14
    v_exp_f32 v44, v44
    v_exp_f32 v45, v45
    v_exp_f32 v46, v46
    v_exp_f32 v47, v47
    v_cvt_pk_bf16_f32 v54, v28, v29
    v_cvt_pk_bf16_f32 v55, v30, v31
    v_cvt_pk_bf16_f32 v62, v44, v45
    v_cvt_pk_bf16_f32 v63, v46, v47
    s_branch L_fb01_1
L_fc01_1_more:
    s_waitcnt lgkmcnt(0)
    v_mfma_f32_16x16x32_bf16 v[128:131], a[68:71], v[52:55], v[128:131]
    v_mfma_f32_16x16x32_bf16 v[132:135], a[76:79], v[52:55], v[132:135]
    v_mfma_f32_16x16x32_bf16 v[136:139], a[84:87], v[52:55], v[136:139]
    v_mfma_f32_16x16x32_bf16 v[140:143], a[92:95], v[52:55], v[140:143]
    v_mfma_f32_16x16x32_bf16 v[144:147], a[100:103], v[52:55], v[144:147]
    v_mfma_f32_16x16x32_bf16 v[148:151], a[108:111], v[52:55], v[148:151]
    v_mfma_f32_16x16x32_bf16 v[152:155], a[116:119], v[52:55], v[152:155]
    v_mfma_f32_16x16x32_bf16 v[156:159], a[124:127], v[52:55], v[156:159]
    v_mfma_f32_16x16x32_bf16 v[160:163], a[68:71], v[60:63], v[160:163]
    v_mfma_f32_16x16x32_bf16 v[164:167], a[76:79], v[60:63], v[164:167]
    v_mfma_f32_16x16x32_bf16 v[168:171], a[84:87], v[60:63], v[168:171]
    v_mfma_f32_16x16x32_bf16 v[172:175], a[92:95], v[60:63], v[172:175]
    v_mfma_f32_16x16x32_bf16 v[176:179], a[100:103], v[60:63], v[176:179]
    v_mfma_f32_16x16x32_bf16 v[180:183], a[108:111], v[60:63], v[180:183]
    v_mfma_f32_16x16x32_bf16 v[184:187], a[116:119], v[60:63], v[184:187]
    v_mfma_f32_16x16x32_bf16 v[188:191], a[124:127], v[60:63], v[188:191]
    s_branch L_fc01_1
L_fa23_1_more:
    ds_read_b128 v[104:107], v80 offset:53248
    ds_read_b128 v[108:111], v81 offset:53248
    ds_read_b128 v[112:115], v82 offset:53248
    ds_read_b128 v[116:119], v83 offset:53248
    s_waitcnt lgkmcnt(0)
    v_mfma_f32_16x16x32_bf16 v[20:23], v[104:107], a[160:163], 0
    v_mfma_f32_16x16x32_bf16 v[20:23], v[108:111], a[164:167], v[20:23]
    v_mfma_f32_16x16x32_bf16 v[20:23], v[112:115], a[168:171], v[20:23]
    v_mfma_f32_16x16x32_bf16 v[20:23], v[116:119], a[172:175], v[20:23]
    v_mfma_f32_16x16x32_bf16 v[36:39], v[104:107], a[176:179], 0
    v_mfma_f32_16x16x32_bf16 v[36:39], v[108:111], a[180:183], v[36:39]
    v_mfma_f32_16x16x32_bf16 v[36:39], v[112:115], a[184:187], v[36:39]
    v_mfma_f32_16x16x32_bf16 v[36:39], v[116:119], a[188:191], v[36:39]
    s_nop 3
    v_cndmask_b32 v20, v102, v20, s[68:69]
    v_cndmask_b32 v21, v102, v21, s[70:71]
    v_cndmask_b32 v22, v102, v22, s[72:73]
    v_cndmask_b32 v23, v102, v23, s[74:75]
    v_max3_f32 v12, v12, v20, v21
    v_max3_f32 v12, v12, v22, v23
    v_cndmask_b32 v36, v102, v36, s[68:69]
    v_cndmask_b32 v37, v102, v37, s[70:71]
    v_cndmask_b32 v38, v102, v38, s[72:73]
    v_cndmask_b32 v39, v102, v39, s[74:75]
    v_max3_f32 v14, v14, v36, v37
    v_max3_f32 v14, v14, v38, v39
    s_cmp_le_u32 s6, 32
    s_cbranch_scc1 L_fa23_1_r
    ds_read_b128 v[104:107], v80 offset:57344
    ds_read_b128 v[108:111], v81 offset:57344
    ds_read_b128 v[112:115], v82 offset:57344
    ds_read_b128 v[116:119], v83 offset:57344
    s_waitcnt lgkmcnt(0)
    v_mfma_f32_16x16x32_bf16 v[24:27], v[104:107], a[160:163], 0
    v_mfma_f32_16x16x32_bf16 v[24:27], v[108:111], a[164:167], v[24:27]
    v_mfma_f32_16x16x32_bf16 v[24:27], v[112:115], a[168:171], v[24:27]
    v_mfma_f32_16x16x32_bf16 v[24:27], v[116:119], a[172:175], v[24:27]
    v_mfma_f32_16x16x32_bf16 v[40:43], v[104:107], a[176:179], 0
    v_mfma_f32_16x16x32_bf16 v[40:43], v[108:111], a[180:183], v[40:43]
    v_mfma_f32_16x16x32_bf16 v[40:43], v[112:115], a[184:187], v[40:43]
    v_mfma_f32_16x16x32_bf16 v[40:43], v[116:119], a[188:191], v[40:43]
    s_nop 3
    v_cndmask_b32 v24, v102, v24, s[76:77]
    v_cndmask_b32 v25, v102, v25, s[78:79]
    v_cndmask_b32 v26, v102, v26, s[80:81]
    v_cndmask_b32 v27, v102, v27, s[82:83]
    v_max3_f32 v12, v12, v24, v25
    v_max3_f32 v12, v12, v26, v27
    v_cndmask_b32 v40, v102, v40, s[76:77]
    v_cndmask_b32 v41, v102, v41, s[78:79]
    v_cndmask_b32 v42, v102, v42, s[80:81]
    v_cndmask_b32 v43, v102, v43, s[82:83]
    v_max3_f32 v14, v14, v40, v41
    v_max3_f32 v14, v14, v42, v43
    s_cmp_le_u32 s6, 48
    s_cbranch_scc1 L_fa23_1_r
    ds_read_b128 v[104:107], v80 offset:61440
    ds_read_b128 v[108:111], v81 offset:61440
    ds_read_b128 v[112:115], v82 offset:61440
    ds_read_b128 v[116:119], v83 offset:61440
    s_waitcnt lgkmcnt(0)
    v_mfma_f32_16x16x32_bf16 v[28:31], v[104:107], a[160:163], 0
    v_mfma_f32_16x16x32_bf16 v[28:31], v[108:111], a[164:167], v[28:31]
    v_mfma_f32_16x16x32_bf16 v[28:31], v[112:115], a[168:171], v[28:31]
    v_mfma_f32_16x16x32_bf16 v[28:31], v[116:119], a[172:175], v[28:31]
    v_mfma_f32_16x16x32_bf16 v[44:47], v[104:107], a[176:179], 0
    v_mfma_f32_16x16x32_bf16 v[44:47], v[108:111], a[180:183], v[44:47]
    v_mfma_f32_16x16x32_bf16 v[44:47], v[112:115], a[184:187], v[44:47]
    v_mfma_f32_16x16x32_bf16 v[44:47], v[116:119], a[188:191], v[44:47]
    s_nop 3
    v_cndmask_b32 v28, v102, v28, s[84:85]
    v_cndmask_b32 v29, v102, v29, s[86:87]
    v_cndmask_b32 v30, v102, v30, s[88:89]
    v_cndmask_b32 v31, v102, v31, s[90:91]
    v_max3_f32 v12, v12, v28, v29
    v_max3_f32 v12, v12, v30, v31
    v_cndmask_b32 v44, v102, v44, s[84:85]
    v_cndmask_b32 v45, v102, v45, s[86:87]
    v_cndmask_b32 v46, v102, v46, s[88:89]
    v_cndmask_b32 v47, v102, v47, s[90:91]
    v_max3_f32 v14, v14, v44, v45
    v_max3_f32 v14, v14, v46, v47
L_fa23_1_r:
    s_branch L_fa23_1
L_fb23_1_more:
    v_sub_f32 v20, v20, v12
    v_sub_f32 v21, v21, v12
    v_sub_f32 v22, v22, v12
    v_sub_f32 v23, v23, v12
    v_exp_f32 v20, v20
    v_exp_f32 v21, v21
    v_exp_f32 v22, v22
    v_exp_f32 v23, v23
    v_sub_f32 v36, v36, v14
    v_sub_f32 v37, v37, v14
    v_sub_f32 v38, v38, v14
    v_sub_f32 v39, v39, v14
    v_exp_f32 v36, v36
    v_exp_f32 v37, v37
    v_exp_f32 v38, v38
    v_exp_f32 v39, v39
    v_cvt_pk_bf16_f32 v50, v20, v21
    v_cvt_pk_bf16_f32 v51, v22, v23
    v_cvt_pk_bf16_f32 v58, v36, v37
    v_cvt_pk_bf16_f32 v59, v38, v39
    s_cmp_le_u32 s6, 32
    s_cbranch_scc1 L_fb23_1
    v_sub_f32 v24, v24, v12
    v_sub_f32 v25, v25, v12
    v_sub_f32 v26, v26, v12
    v_sub_f32 v27, v27, v12
    v_exp_f32 v24, v24
    v_exp_f32 v25, v25
    v_exp_f32 v26, v26
    v_exp_f32 v27, v27
    v_sub_f32 v40, v40, v14
    v_sub_f32 v41, v41, v14
    v_sub_f32 v42, v42, v14
    v_sub_f32 v43, v43, v14
    v_exp_f32 v40, v40
    v_exp_f32 v41, v41
    v_exp_f32 v42, v42
    v_exp_f32 v43, v43
    v_cvt_pk_bf16_f32 v52, v24, v25
    v_cvt_pk_bf16_f32 v53, v26, v27
    v_cvt_pk_bf16_f32 v60, v40, v41
    v_cvt_pk_bf16_f32 v61, v42, v43
    s_cmp_le_u32 s6, 48
    s_cbranch_scc1 L_fb23_1
    v_sub_f32 v28, v28, v12
    v_sub_f32 v29, v29, v12
    v_sub_f32 v30, v30, v12
    v_sub_f32 v31, v31, v12
    v_exp_f32 v28, v28
    v_exp_f32 v29, v29
    v_exp_f32 v30, v30
    v_exp_f32 v31, v31
    v_sub_f32 v44, v44, v14
    v_sub_f32 v45, v45, v14
    v_sub_f32 v46, v46, v14
    v_sub_f32 v47, v47, v14
    v_cvt_pk_bf16_f32 v54, v28, v29
    v_cvt_pk_bf16_f32 v55, v30, v31
    s_branch L_fb23_1
L_fc2_1_more:
    s_waitcnt lgkmcnt(0)
    v_mfma_f32_16x16x32_bf16 v[192:195], a[68:71], v[52:55], v[192:195]
    v_mfma_f32_16x16x32_bf16 v[196:199], a[76:79], v[52:55], v[196:199]
    v_mfma_f32_16x16x32_bf16 v[200:203], a[84:87], v[52:55], v[200:203]
    v_mfma_f32_16x16x32_bf16 v[204:207], a[92:95], v[52:55], v[204:207]
    v_mfma_f32_16x16x32_bf16 v[208:211], a[100:103], v[52:55], v[208:211]
    v_mfma_f32_16x16x32_bf16 v[212:215], a[108:111], v[52:55], v[212:215]
    v_mfma_f32_16x16x32_bf16 v[216:219], a[116:119], v[52:55], v[216:219]
    v_mfma_f32_16x16x32_bf16 v[220:223], a[124:127], v[52:55], v[220:223]
    s_branch L_fc2_1
L_fa01_0_more:
    ds_read_b128 v[104:107], v80 offset:53248
    ds_read_b128 v[108:111], v81 offset:53248
    ds_read_b128 v[112:115], v82 offset:53248
    ds_read_b128 v[116:119], v83 offset:53248
    s_waitcnt lgkmcnt(0)
    v_mfma_f32_16x16x32_bf16 v[20:23], v[104:107], a[128:131], 0
    v_mfma_f32_16x16x32_bf16 v[20:23], v[108:111], a[132:135], v[20:23]
    v_mfma_f32_16x16x32_bf16 v[20:23], v[112:115], a[136:139], v[20:23]
    v_mfma_f32_16x16x32_bf16 v[20:23], v[116:119], a[140:143], v[20:23]
    v_mfma_f32_16x16x32_bf16 v[36:39], v[104:107], a[144:147], 0
    v_mfma_f32_16x16x32_bf16 v[36:39], v[108:111], a[148:151], v[36:39]
    v_mfma_f32_16x16x32_bf16 v[36:39], v[112:115], a[152:155], v[36:39]
    v_mfma_f32_16x16x32_bf16 v[36:39], v[116:119], a[156:159], v[36:39]
    s_nop 3
    v_cndmask_b32 v20, v102, v20, s[68:69]
    v_cndmask_b32 v21, v102, v21, s[70:71]
    v_cndmask_b32 v22, v102, v22, s[72:73]
    v_cndmask_b32 v23, v102, v23, s[74:75]
    v_max3_f32 v12, v12, v20, v21
    v_max3_f32 v12, v12, v22, v23
    v_cndmask_b32 v36, v102, v36, s[68:69]
    v_cndmask_b32 v37, v102, v37, s[70:71]
    v_cndmask_b32 v38, v102, v38, s[72:73]
    v_cndmask_b32 v39, v102, v39, s[74:75]
    v_max3_f32 v14, v14, v36, v37
    v_max3_f32 v14, v14, v38, v39
    s_cmp_le_u32 s6, 32
    s_cbranch_scc1 L_fa01_0_r
    ds_read_b128 v[104:107], v80 offset:57344
    ds_read_b128 v[108:111], v81 offset:57344
    ds_read_b128 v[112:115], v82 offset:57344
    ds_read_b128 v[116:119], v83 offset:57344
    s_waitcnt lgkmcnt(0)
    v_mfma_f32_16x16x32_bf16 v[24:27], v[104:107], a[128:131], 0
    v_mfma_f32_16x16x32_bf16 v[24:27], v[108:111], a[132:135], v[24:27]
    v_mfma_f32_16x16x32_bf16 v[24:27], v[112:115], a[136:139], v[24:27]
    v_mfma_f32_16x16x32_bf16 v[24:27], v[116:119], a[140:143], v[24:27]
    v_mfma_f32_16x16x32_bf16 v[40:43], v[104:107], a[144:147], 0
    v_mfma_f32_16x16x32_bf16 v[40:43], v[108:111], a[148:151], v[40:43]
    v_mfma_f32_16x16x32_bf16 v[40:43], v[112:115], a[152:155], v[40:43]
    v_mfma_f32_16x16x32_bf16 v[40:43], v[116:119], a[156:159], v[40:43]
    s_nop 3
    v_cndmask_b32 v24, v102, v24, s[76:77]
    v_cndmask_b32 v25, v102, v25, s[78:79]
    v_cndmask_b32 v26, v102, v26, s[80:81]
    v_cndmask_b32 v27, v102, v27, s[82:83]
    v_max3_f32 v12, v12, v24, v25
    v_max3_f32 v12, v12, v26, v27
    v_cndmask_b32 v40, v102, v40, s[76:77]
    v_cndmask_b32 v41, v102, v41, s[78:79]
    v_cndmask_b32 v42, v102, v42, s[80:81]
    v_cndmask_b32 v43, v102, v43, s[82:83]
    v_max3_f32 v14, v14, v40, v41
    v_max3_f32 v14, v14, v42, v43
    s_cmp_le_u32 s6, 48
    s_cbranch_scc1 L_fa01_0_r
    ds_read_b128 v[104:107], v80 offset:61440
    ds_read_b128 v[108:111], v81 offset:61440
    ds_read_b128 v[112:115], v82 offset:61440
    ds_read_b128 v[116:119], v83 offset:61440
    s_waitcnt lgkmcnt(0)
    v_mfma_f32_16x16x32_bf16 v[28:31], v[104:107], a[128:131], 0
    v_mfma_f32_16x16x32_bf16 v[28:31], v[108:111], a[132:135], v[28:31]
    v_mfma_f32_16x16x32_bf16 v[28:31], v[112:115], a[136:139], v[28:31]
    v_mfma_f32_16x16x32_bf16 v[28:31], v[116:119], a[140:143], v[28:31]
    v_mfma_f32_16x16x32_bf16 v[44:47], v[104:107], a[144:147], 0
    v_mfma_f32_16x16x32_bf16 v[44:47], v[108:111], a[148:151], v[44:47]
    v_mfma_f32_16x16x32_bf16 v[44:47], v[112:115], a[152:155], v[44:47]
    v_mfma_f32_16x16x32_bf16 v[44:47], v[116:119], a[156:159], v[44:47]
    s_nop 3
    v_cndmask_b32 v28, v102, v28, s[84:85]
    v_cndmask_b32 v29, v102, v29, s[86:87]
    v_cndmask_b32 v30, v102, v30, s[88:89]
    v_cndmask_b32 v31, v102, v31, s[90:91]
    v_max3_f32 v12, v12, v28, v29
    v_max3_f32 v12, v12, v30, v31
    v_cndmask_b32 v44, v102, v44, s[84:85]
    v_cndmask_b32 v45, v102, v45, s[86:87]
    v_cndmask_b32 v46, v102, v46, s[88:89]
    v_cndmask_b32 v47, v102, v47, s[90:91]
    v_max3_f32 v14, v14, v44, v45
    v_max3_f32 v14, v14, v46, v47
L_fa01_0_r:
    ds_read_b128 v[104:107], v80 offset:49152
    ds_read_b128 v[108:111], v81 offset:49152
    ds_read_b128 v[112:115], v82 offset:49152
    ds_read_b128 v[116:119], v83 offset:49152
    s_branch L_fa01_0
L_fb01_0_more:
    v_sub_f32 v20, v20, v12
    v_sub_f32 v21, v21, v12
    v_sub_f32 v22, v22, v12
    v_sub_f32 v23, v23, v12
    v_exp_f32 v20, v20
    v_exp_f32 v21, v21
    v_exp_f32 v22, v22
    v_exp_f32 v23, v23
    v_sub_f32 v36, v36, v14
    v_sub_f32 v37, v37, v14
    v_sub_f32 v38, v38, v14
    v_sub_f32 v39, v39, v14
    v_exp_f32 v36, v36
    v_exp_f32 v37, v37
    v_exp_f32 v38, v38
    v_exp_f32 v39, v39
    v_cvt_pk_bf16_f32 v50, v20, v21
    v_cvt_pk_bf16_f32 v51, v22, v23
    v_cvt_pk_bf16_f32 v58, v36, v37
    v_cvt_pk_bf16_f32 v59, v38, v39
    s_cmp_le_u32 s6, 32
    s_cbranch_scc1 L_fb01_0
    v_sub_f32 v24, v24, v12
    v_sub_f32 v25, v25, v12
    v_sub_f32 v26, v26, v12
    v_sub_f32 v27, v27, v12
    v_exp_f32 v24, v24
    v_exp_f32 v25, v25
    v_exp_f32 v26, v26
    v_exp_f32 v27, v27
    v_sub_f32 v40, v40, v14
    v_sub_f32 v41, v41, v14
    v_sub_f32 v42, v42, v14
    v_sub_f32 v43, v43, v14
    v_exp_f32 v40, v40
    v_exp_f32 v41, v41
    v_exp_f32 v42, v42
    v_exp_f32 v43, v43
    v_cvt_pk_bf16_f32 v52, v24, v25
    v_cvt_pk_bf16_f32 v53, v26, v27
    v_cvt_pk_bf16_f32 v60, v40, v41
    v_cvt_pk_bf16_f32 v61, v42, v43
    s_cmp_le_u32 s6, 48
    s_cbranch_scc1 L_fb01_0
    v_sub_f32 v28, v28, v12
    v_sub_f32 v29, v29, v12
    v_sub_f32 v30, v30, v12
    v_sub_f32 v31, v31, v12
    v_exp_f32 v28, v28
    v_exp_f32 v29, v29
    v_exp_f32 v30, v30
    v_exp_f32 v31, v31
    v_sub_f32 v44, v44, v14
    v_sub_f32 v45, v45, v14
    v_sub_f32 v46, v46, v14
    v_sub_f32 v47, v47, v14
    v_exp_f32 v44, v44
    v_exp_f32 v45, v45
    v_exp_f32 v46, v46
    v_exp_f32 v47, v47
    v_cvt_pk_bf16_f32 v54, v28, v29
    v_cvt_pk_bf16_f32 v55, v30, v31
    v_cvt_pk_bf16_f32 v62, v44, v45
    v_cvt_pk_bf16_f32 v63, v46, v47
    s_branch L_fb01_0
L_fc01_0_more:
    s_waitcnt lgkmcnt(0)
    v_mfma_f32_16x16x32_bf16 v[128:131], a[68:71], v[52:55], v[128:131]
    v_mfma_f32_16x16x32_bf16 v[132:135], a[76:79], v[52:55], v[132:135]
    v_mfma_f32_16x16x32_bf16 v[136:139], a[84:87], v[52:55], v[136:139]
    v_mfma_f32_16x16x32_bf16 v[140:143], a[92:95], v[52:55], v[140:143]
    v_mfma_f32_16x16x32_bf16 v[144:147], a[100:103], v[52:55], v[144:147]
    v_mfma_f32_16x16x32_bf16 v[148:151], a[108:111], v[52:55], v[148:151]
    v_mfma_f32_16x16x32_bf16 v[152:155], a[116:119], v[52:55], v[152:155]
    v_mfma_f32_16x16x32_bf16 v[156:159], a[124:127], v[52:55], v[156:159]
    v_mfma_f32_16x16x32_bf16 v[160:163], a[68:71], v[60:63], v[160:163]
    v_mfma_f32_16x16x32_bf16 v[164:167], a[76:79], v[60:63], v[164:167]
    v_mfma_f32_16x16x32_bf16 v[168:171], a[84:87], v[60:63], v[168:171]
    v_mfma_f32_16x16x32_bf16 v[172:175], a[92:95], v[60:63], v[172:175]
    v_mfma_f32_16x16x32_bf16 v[176:179], a[100:103], v[60:63], v[176:179]
    v_mfma_f32_16x16x32_bf16 v[180:183], a[108:111], v[60:63], v[180:183]
    v_mfma_f32_16x16x32_bf16 v[184:187], a[116:119], v[60:63], v[184:187]
    v_mfma_f32_16x16x32_bf16 v[188:191], a[124:127], v[60:63], v[188:191]
    s_branch L_fc01_0
L_fa23_0_more:
    ds_read_b128 v[104:107], v80 offset:53248
    ds_read_b128 v[108:111], v81 offset:53248
    ds_read_b128 v[112:115], v82 offset:53248
    ds_read_b128 v[116:119], v83 offset:53248
    s_waitcnt lgkmcnt(0)
    v_mfma_f32_16x16x32_bf16 v[20:23], v[104:107], a[160:163], 0
    v_mfma_f32_16x16x32_bf16 v[20:23], v[108:111], a[164:167], v[20:23]
    v_mfma_f32_16x16x32_bf16 v[20:23], v[112:115], a[168:171], v[20:23]
    v_mfma_f32_16x16x32_bf16 v[20:23], v[116:119], a[172:175], v[20:23]
    v_mfma_f32_16x16x32_bf16 v[36:39], v[104:107], a[176:179], 0
    v_mfma_f32_16x16x32_bf16 v[36:39], v[108:111], a[180:183], v[36:39]
    v_mfma_f32_16x16x32_bf16 v[36:39], v[112:115], a[184:187], v[36:39]
    v_mfma_f32_16x16x32_bf16 v[36:39], v[116:119], a[188:191], v[36:39]
    s_nop 3
    v_cndmask_b32 v20, v102, v20, s[68:69]
    v_cndmask_b32 v21, v102, v21, s[70:71]
    v_cndmask_b32 v22, v102, v22, s[72:73]
    v_cndmask_b32 v23, v102, v23, s[74:75]
    v_max3_f32 v12, v12, v20, v21
    v_max3_f32 v12, v12, v22, v23
    v_cndmask_b32 v36, v102, v36, s[68:69]
    v_cndmask_b32 v37, v102, v37, s[70:71]
    v_cndmask_b32 v38, v102, v38, s[72:73]
    v_cndmask_b32 v39, v102, v39, s[74:75]
    v_max3_f32 v14, v14, v36, v37
    v_max3_f32 v14, v14, v38, v39
    s_cmp_le_u32 s6, 32
    s_cbranch_scc1 L_fa23_0_r
    ds_read_b128 v[104:107], v80 offset:57344
    ds_read_b128 v[108:111], v81 offset:57344
    ds_read_b128 v[112:115], v82 offset:57344
    ds_read_b128 v[116:119], v83 offset:57344
    s_waitcnt lgkmcnt(0)
    v_mfma_f32_16x16x32_bf16 v[24:27], v[104:107], a[160:163], 0
    v_mfma_f32_16x16x32_bf16 v[24:27], v[108:111], a[164:167], v[24:27]
    v_mfma_f32_16x16x32_bf16 v[24:27], v[112:115], a[168:171], v[24:27]
    v_mfma_f32_16x16x32_bf16 v[24:27], v[116:119], a[172:175], v[24:27]
    v_mfma_f32_16x16x32_bf16 v[40:43], v[104:107], a[176:179], 0
    v_mfma_f32_16x16x32_bf16 v[40:43], v[108:111], a[180:183], v[40:43]
    v_mfma_f32_16x16x32_bf16 v[40:43], v[112:115], a[184:187], v[40:43]
    v_mfma_f32_16x16x32_bf16 v[40:43], v[116:119], a[188:191], v[40:43]
    s_nop 3
    v_cndmask_b32 v24, v102, v24, s[76:77]
    v_cndmask_b32 v25, v102, v25, s[78:79]
    v_cndmask_b32 v26, v102, v26, s[80:81]
    v_cndmask_b32 v27, v102, v27, s[82:83]
    v_max3_f32 v12, v12, v24, v25
    v_max3_f32 v12, v12, v26, v27
    v_cndmask_b32 v40, v102, v40, s[76:77]
    v_cndmask_b32 v41, v102, v41, s[78:79]
    v_cndmask_b32 v42, v102, v42, s[80:81]
    v_cndmask_b32 v43, v102, v43, s[82:83]
    v_max3_f32 v14, v14, v40, v41
    v_max3_f32 v14, v14, v42, v43
    s_cmp_le_u32 s6, 48
    s_cbranch_scc1 L_fa23_0_r
    ds_read_b128 v[104:107], v80 offset:61440
    ds_read_b128 v[108:111], v81 offset:61440
    ds_read_b128 v[112:115], v82 offset:61440
    ds_read_b128 v[116:119], v83 offset:61440
    s_waitcnt lgkmcnt(0)
    v_mfma_f32_16x16x32_bf16 v[28:31], v[104:107], a[160:163], 0
    v_mfma_f32_16x16x32_bf16 v[28:31], v[108:111], a[164:167], v[28:31]
    v_mfma_f32_16x16x32_bf16 v[28:31], v[112:115], a[168:171], v[28:31]
    v_mfma_f32_16x16x32_bf16 v[28:31], v[116:119], a[172:175], v[28:31]
    v_mfma_f32_16x16x32_bf16 v[44:47], v[104:107], a[176:179], 0
    v_mfma_f32_16x16x32_bf16 v[44:47], v[108:111], a[180:183], v[44:47]
    v_mfma_f32_16x16x32_bf16 v[44:47], v[112:115], a[184:187], v[44:47]
    v_mfma_f32_16x16x32_bf16 v[44:47], v[116:119], a[188:191], v[44:47]
    s_nop 3
    v_cndmask_b32 v28, v102, v28, s[84:85]
    v_cndmask_b32 v29, v102, v29, s[86:87]
    v_cndmask_b32 v30, v102, v30, s[88:89]
    v_cndmask_b32 v31, v102, v31, s[90:91]
    v_max3_f32 v12, v12, v28, v29
    v_max3_f32 v12, v12, v30, v31
    v_cndmask_b32 v44, v102, v44, s[84:85]
    v_cndmask_b32 v45, v102, v45, s[86:87]
    v_cndmask_b32 v46, v102, v46, s[88:89]
    v_cndmask_b32 v47, v102, v47, s[90:91]
    v_max3_f32 v14, v14, v44, v45
    v_max3_f32 v14, v14, v46, v47
L_fa23_0_r:
    s_branch L_fa23_0
L_fb23_0_more:
    v_sub_f32 v20, v20, v12
    v_sub_f32 v21, v21, v12
    v_sub_f32 v22, v22, v12
    v_sub_f32 v23, v23, v12
    v_exp_f32 v20, v20
    v_exp_f32 v21, v21
    v_exp_f32 v22, v22
    v_exp_f32 v23, v23
    v_sub_f32 v36, v36, v14
    v_sub_f32 v37, v37, v14
    v_sub_f32 v38, v38, v14
    v_sub_f32 v39, v39, v14
    v_exp_f32 v36, v36
    v_exp_f32 v37, v37
    v_exp_f32 v38, v38
    v_exp_f32 v39, v39
    v_cvt_pk_bf16_f32 v50, v20, v21
    v_cvt_pk_bf16_f32 v51, v22, v23
    v_cvt_pk_bf16_f32 v58, v36, v37
    v_cvt_pk_bf16_f32 v59, v38, v39
    s_cmp_le_u32 s6, 32
    s_cbranch_scc1 L_fb23_0
    v_sub_f32 v24, v24, v12
    v_sub_f32 v25, v25, v12
    v_sub_f32 v26, v26, v12
    v_sub_f32 v27, v27, v12
    v_exp_f32 v24, v24
    v_exp_f32 v25, v25
    v_exp_f32 v26, v26
    v_exp_f32 v27, v27
    v_sub_f32 v40, v40, v14
    v_sub_f32 v41, v41, v14
    v_sub_f32 v42, v42, v14
    v_sub_f32 v43, v43, v14
    v_exp_f32 v40, v40
    v_exp_f32 v41, v41
    v_exp_f32 v42, v42
    v_exp_f32 v43, v43
    v_cvt_pk_bf16_f32 v52, v24, v25
    v_cvt_pk_bf16_f32 v53, v26, v27
    v_cvt_pk_bf16_f32 v60, v40, v41
    v_cvt_pk_bf16_f32 v61, v42, v43
    s_cmp_le_u32 s6, 48
    s_cbranch_scc1 L_fb23_0
    v_sub_f32 v28, v28, v12
    v_sub_f32 v29, v29, v12
    v_sub_f32 v30, v30, v12
    v_sub_f32 v31, v31, v12
    v_exp_f32 v28, v28
    v_exp_f32 v29, v29
    v_exp_f32 v30, v30
    v_exp_f32 v31, v31
    v_sub_f32 v44, v44, v14
    v_sub_f32 v45, v45, v14
    v_sub_f32 v46, v46, v14
    v_sub_f32 v47, v47, v14
    v_cvt_pk_bf16_f32 v54, v28, v29
    v_cvt_pk_bf16_f32 v55, v30, v31
    s_branch L_fb23_0
L_fc2_0_more:
    s_waitcnt lgkmcnt(0)
    v_mfma_f32_16x16x32_bf16 v[192:195], a[68:71], v[52:55], v[192:195]
    v_mfma_f32_16x16x32_bf16 v[196:199], a[76:79], v[52:55], v[196:199]
    v_mfma_f32_16x16x32_bf16 v[200:203], a[84:87], v[52:55], v[200:203]
    v_mfma_f32_16x16x32_bf16 v[204:207], a[92:95], v[52:55], v[204:207]
    v_mfma_f32_16x16x32_bf16 v[208:211], a[100:103], v[52:55], v[208:211]
    v_mfma_f32_16x16x32_bf16 v[212:215], a[108:111], v[52:55], v[212:215]
    v_mfma_f32_16x16x32_bf16 v[216:219], a[116:119], v[52:55], v[216:219]
    v_mfma_f32_16x16x32_bf16 v[220:223], a[124:127], v[52:55], v[220:223]
    s_branch L_fc2_0
L_short:
    s_cmp_eq_u32 s5, 2
    s_cbranch_scc1 L_last
L_drain:
    v_exp_f32 v44, v44
    v_exp_f32 v45, v45
    v_exp_f32 v46, v46
    v_exp_f32 v47, v47
    s_lshl_b32 s7, s3, 13
    v_cvt_pk_bf16_f32 v62, v44, v45
    v_cvt_pk_bf16_f32 v63, v46, v47
    s_add_u32 s7, s7, 131072
    s_nop 0
    v_smfmac_f32_16x16x64_bf16 a[204:207], a[208:211], v[56:63], v101
    v_mov_b32 v103, 0x4e800000
    v_accvgpr_read_b32 v104, a192
    v_mfma_f32_16x16x32_bf16 v[224:227], a[64:67], v[56:59], v[224:227]
    v_accvgpr_read_b32 v105, a193
    v_add_f32 v104, v104, v105
    v_mfma_f32_16x16x32_bf16 v[224:227], a[68:71], v[60:63], v[224:227]
    v_accvgpr_read_b32 v106, a196
    v_accvgpr_read_b32 v107, a197
    v_mfma_f32_16x16x32_bf16 v[228:231], a[76:79], v[60:63], v[228:231]
    v_add_f32 v106, v106, v107
    v_accvgpr_read_b32 v108, a200
    v_mfma_f32_16x16x32_bf16 v[228:231], a[72:75], v[56:59], v[228:231]
    v_accvgpr_read_b32 v109, a201
    v_add_f32 v108, v108, v109
    v_mfma_f32_16x16x32_bf16 v[232:235], a[80:83], v[56:59], v[232:235]
    v_lshrrev_b32 v1, 5, v2
    v_and_b32 v11, 7, v4
    v_mfma_f32_16x16x32_bf16 v[232:235], a[84:87], v[60:63], v[232:235]
    v_xor_b32 v1, v1, v11
    v_and_b32 v11, 1, v3
    v_mfma_f32_16x16x32_bf16 v[236:239], a[92:95], v[60:63], v[236:239]
    v_lshl_add_u32 v1, v11, 3, v1
    v_lshlrev_b32 v1, 4, v1
    v_mfma_f32_16x16x32_bf16 v[236:239], a[88:91], v[56:59], v[236:239]
    v_lshl_add_u32 v1, v4, 8, v1
    v_add_u32 v120, s7, v1
    v_mfma_f32_16x16x32_bf16 v[240:243], a[96:99], v[56:59], v[240:243]
    v_accvgpr_read_b32 v110, a204
    v_accvgpr_read_b32 v111, a205
    v_mfma_f32_16x16x32_bf16 v[240:243], a[100:103], v[60:63], v[240:243]
    v_add_f32 v110, v110, v111
    v_xor_b32 v121, 32, v120
    v_mfma_f32_16x16x32_bf16 v[244:247], a[108:111], v[60:63], v[244:247]
    v_xor_b32 v122, 64, v120
    v_xor_b32 v123, 96, v120
    v_mfma_f32_16x16x32_bf16 v[244:247], a[104:107], v[56:59], v[244:247]
    v_lshrrev_b32 v1, 2, v4
    v_and_b32 v11, 1, v4
    v_mfma_f32_16x16x32_bf16 v[248:251], a[112:115], v[56:59], v[248:251]
    v_lshl_add_u32 v1, v1, 1, v11
    v_xor_b32 v1, v1, v3
    v_mfma_f32_16x16x32_bf16 v[248:251], a[116:119], v[60:63], v[248:251]
    v_bfe_u32 v11, v4, 1, 1
    v_lshl_add_u32 v1, v1, 1, v11
    v_mfma_f32_16x16x32_bf16 v[252:255], a[124:127], v[60:63], v[252:255]
    v_lshlrev_b32 v1, 3, v1
    v_lshl_add_u32 v1, v3, 8, v1
    v_mfma_f32_16x16x32_bf16 v[252:255], a[120:123], v[56:59], v[252:255]
    v_add_u32 v5, s7, v1
    v_xor_b32 v6, 0x440, v5
    v_xor_b32 v7, 0x800, v5
    v_xor_b32 v8, 0xc40, v5
    v_xor_b32 v124, 0x1000, v5
    v_xor_b32 v125, 0x1000, v6
    v_xor_b32 v126, 0x1000, v7
    v_xor_b32 v127, 0x1000, v8
    v_lshlrev_b32 v9, 4, v2
    v_max3_f32 v1, v104, v106, v108
    v_add_f32 v11, v104, v106
    v_max_f32 v1, v1, v110
    v_add_f32 v10, v108, v110
    v_cmp_nle_f32 vcc, v1, v103
    v_add_f32 v11, v11, v10
    v_cmp_u_f32 s[60:61], v11, v11
    v_rcp_f32 v104, v104
    v_rcp_f32 v106, v106
    v_rcp_f32 v108, v108
    v_rcp_f32 v110, v110
    s_or_b64 vcc, vcc, s[60:61]
    s_cbranch_vccnz L_slow
L_epi_ok:
    v_accvgpr_read_b32 v1, a228
    v_mov_b32 v105, v104
    v_mul_f32_e64 v112, -v1, v104
    v_mov_b32 v113, v112
    v_mov_b32 v107, v106
    v_mul_f32_e64 v114, -v1, v106
    v_mov_b32 v115, v114
    v_mov_b32 v109, v108
    v_mul_f32_e64 v116, -v1, v108
    v_mov_b32 v117, v116
    v_mov_b32 v111, v110
    v_mul_f32_e64 v118, -v1, v110
    v_mov_b32 v119, v118
    v_pk_fma_f32 v[128:129], v[128:129], v[104:105], v[112:113]
    v_pk_fma_f32 v[130:131], v[130:131], v[104:105], v[112:113]
    v_pk_fma_f32 v[132:133], v[132:133], v[104:105], v[112:113]
    v_pk_fma_f32 v[134:135], v[134:135], v[104:105], v[112:113]
    v_cvt_pk_bf16_f32 v128, v128, v129
    v_cvt_pk_bf16_f32 v129, v130, v131
    v_cvt_pk_bf16_f32 v130, v132, v133
    v_cvt_pk_bf16_f32 v131, v134, v135
    v_pk_fma_f32 v[136:137], v[136:137], v[104:105], v[112:113]
    v_pk_fma_f32 v[138:139], v[138:139], v[104:105], v[112:113]
    v_pk_fma_f32 v[140:141], v[140:141], v[104:105], v[112:113]
    v_pk_fma_f32 v[142:143], v[142:143], v[104:105], v[112:113]
    v_cvt_pk_bf16_f32 v136, v136, v137
    v_cvt_pk_bf16_f32 v137, v138, v139
    v_cvt_pk_bf16_f32 v138, v140, v141
    v_cvt_pk_bf16_f32 v139, v142, v143
    ds_write_b128 v120, v[128:131] offset:0
    v_pk_fma_f32 v[144:145], v[144:145], v[104:105], v[112:113]
    v_pk_fma_f32 v[146:147], v[146:147], v[104:105], v[112:113]
    v_pk_fma_f32 v[148:149], v[148:149], v[104:105], v[112:113]
    v_pk_fma_f32 v[150:151], v[150:151], v[104:105], v[112:113]
    v_cvt_pk_bf16_f32 v144, v144, v145
    v_cvt_pk_bf16_f32 v145, v146, v147
    v_cvt_pk_bf16_f32 v146, v148, v149
    v_cvt_pk_bf16_f32 v147, v150, v151
    ds_write_b128 v121, v[136:139] offset:0
    v_pk_fma_f32 v[152:153], v[152:153], v[104:105], v[112:113]
    v_pk_fma_f32 v[154:155], v[154:155], v[104:105], v[112:113]
    v_pk_fma_f32 v[156:157], v[156:157], v[104:105], v[112:113]
    v_pk_fma_f32 v[158:159], v[158:159], v[104:105], v[112:113]
    v_cvt_pk_bf16_f32 v152, v152, v153
    v_cvt_pk_bf16_f32 v153, v154, v155
    v_cvt_pk_bf16_f32 v154, v156, v157
    v_cvt_pk_bf16_f32 v155, v158, v159
    ds_write_b128 v122, v[144:147] offset:0
    v_pk_fma_f32 v[160:161], v[160:161], v[106:107], v[114:115]
    v_pk_fma_f32 v[162:163], v[162:163], v[106:107], v[114:115]
    v_pk_fma_f32 v[164:165], v[164:165], v[106:107], v[114:115]
    v_pk_fma_f32 v[166:167], v[166:167], v[106:107], v[114:115]
    v_cvt_pk_bf16_f32 v160, v160, v161
    v_cvt_pk_bf16_f32 v161, v162, v163
    v_cvt_pk_bf16_f32 v162, v164, v165
    v_cvt_pk_bf16_f32 v163, v166, v167
    ds_write_b128 v123, v[152:155] offset:0
    ds_read2_b64 v[132:135], v5 offset0:0 offset1:16
    ds_read2_b64 v[140:143], v6 offset0:0 offset1:16
    ds_read2_b64 v[148:151], v7 offset0:0 offset1:16
    ds_read2_b64 v[156:159], v8 offset0:0 offset1:16
    v_pk_fma_f32 v[168:169], v[168:169], v[106:107], v[114:115]
    v_pk_fma_f32 v[170:171], v[170:171], v[106:107], v[114:115]
    v_pk_fma_f32 v[172:173], v[172:173], v[106:107], v[114:115]
    v_pk_fma_f32 v[174:175], v[174:175], v[106:107], v[114:115]
    v_cvt_pk_bf16_f32 v168, v168, v169
    v_cvt_pk_bf16_f32 v169, v170, v171
    v_cvt_pk_bf16_f32 v170, v172, v173
    v_cvt_pk_bf16_f32 v171, v174, v175
    ds_write_b128 v120, v[160:163] offset:4096
    v_pk_fma_f32 v[176:177], v[176:177], v[106:107], v[114:115]
    v_pk_fma_f32 v[178:179], v[178:179], v[106:107], v[114:115]
    v_pk_fma_f32 v[180:181], v[180:181], v[106:107], v[114:115]
    v_pk_fma_f32 v[182:183], v[182:183], v[106:107], v[114:115]
    v_cvt_pk_bf16_f32 v176, v176, v177
    v_cvt_pk_bf16_f32 v177, v178, v179
    v_cvt_pk_bf16_f32 v178, v180, v181
    v_cvt_pk_bf16_f32 v179, v182, v183
    ds_write_b128 v121, v[168:171] offset:4096
    v_pk_fma_f32 v[184:185], v[184:185], v[106:107], v[114:115]
    v_pk_fma_f32 v[186:187], v[186:187], v[106:107], v[114:115]
    v_pk_fma_f32 v[188:189], v[188:189], v[106:107], v[114:115]
    v_pk_fma_f32 v[190:191], v[190:191], v[106:107], v[114:115]
    v_cvt_pk_bf16_f32 v184, v184, v185
    v_cvt_pk_bf16_f32 v185, v186, v187
    v_cvt_pk_bf16_f32 v186, v188, v189
    v_cvt_pk_bf16_f32 v187, v190, v191
    s_waitcnt lgkmcnt(2)
    buffer_store_dwordx4 v[132:135], v9, s[48:51], s14 offen sc0 sc1 nt
    ds_write_b128 v122, v[176:179] offset:4096
    v_pk_fma_f32 v[192:193], v[192:193], v[108:109], v[116:117]
    v_pk_fma_f32 v[194:195], v[194:195], v[108:109], v[116:117]
    v_pk_fma_f32 v[196:197], v[196:197], v[108:109], v[116:117]
    v_pk_fma_f32 v[198:199], v[198:199], v[108:109], v[116:117]
    v_cvt_pk_bf16_f32 v192, v192, v193
    v_cvt_pk_bf16_f32 v193, v194, v195
    v_cvt_pk_bf16_f32 v194, v196, v197
    v_cvt_pk_bf16_f32 v195, v198, v199
    buffer_store_dwordx4 v[140:143], v9, s[48:51], s14 offen offset:1024 sc0 sc1 nt
    ds_write_b128 v123, v[184:187] offset:4096
    ds_read2_b64 v[164:167], v124 offset0:0 offset1:16
    ds_read2_b64 v[172:175], v125 offset0:0 offset1:16
    ds_read2_b64 v[180:183], v126 offset0:0 offset1:16
    ds_read2_b64 v[188:191], v127 offset0:0 offset1:16
    v_pk_fma_f32 v[200:201], v[200:201], v[108:109], v[116:117]
    v_pk_fma_f32 v[202:203], v[202:203], v[108:109], v[116:117]
    v_pk_fma_f32 v[204:205], v[204:205], v[108:109], v[116:117]
    v_pk_fma_f32 v[206:207], v[206:207], v[108:109], v[116:117]
    v_cvt_pk_bf16_f32 v200, v200, v201
    v_cvt_pk_bf16_f32 v201, v202, v203
    v_cvt_pk_bf16_f32 v202, v204, v205
    v_cvt_pk_bf16_f32 v203, v206, v207
    buffer_store_dwordx4 v[148:151], v9, s[48:51], s14 offen offset:2048 sc0 sc1 nt
    ds_write_b128 v120, v[192:195] offset:0
    v_pk_fma_f32 v[208:209], v[208:209], v[108:109], v[116:117]
    v_pk_fma_f32 v[210:211], v[210:211], v[108:109], v[116:117]
    v_pk_fma_f32 v[212:213], v[212:213], v[108:109], v[116:117]
    v_pk_fma_f32 v[214:215], v[214:215], v[108:109], v[116:117]
    v_cvt_pk_bf16_f32 v208, v208, v209
    v_cvt_pk_bf16_f32 v209, v210, v211
    v_cvt_pk_bf16_f32 v210, v212, v213
    v_cvt_pk_bf16_f32 v211, v214, v215
    buffer_store_dwordx4 v[156:159], v9, s[48:51], s14 offen offset:3072 sc0 sc1 nt
    ds_write_b128 v121, v[200:203] offset:0
    v_pk_fma_f32 v[216:217], v[216:217], v[108:109], v[116:117]
    v_pk_fma_f32 v[218:219], v[218:219], v[108:109], v[116:117]
    v_pk_fma_f32 v[220:221], v[220:221], v[108:109], v[116:117]
    v_pk_fma_f32 v[222:223], v[222:223], v[108:109], v[116:117]
    v_cvt_pk_bf16_f32 v216, v216, v217
    v_cvt_pk_bf16_f32 v217, v218, v219
    v_cvt_pk_bf16_f32 v218, v220, v221
    v_cvt_pk_bf16_f32 v219, v222, v223
    s_waitcnt lgkmcnt(2)
    buffer_store_dwordx4 v[164:167], v9, s[48:51], s45 offen sc0 sc1 nt
    ds_write_b128 v122, v[208:211] offset:0
    v_pk_fma_f32 v[224:225], v[224:225], v[110:111], v[118:119]
    v_pk_fma_f32 v[226:227], v[226:227], v[110:111], v[118:119]
    v_pk_fma_f32 v[228:229], v[228:229], v[110:111], v[118:119]
    v_pk_fma_f32 v[230:231], v[230:231], v[110:111], v[118:119]
    v_cvt_pk_bf16_f32 v224, v224, v225
    v_cvt_pk_bf16_f32 v225, v226, v227
    v_cvt_pk_bf16_f32 v226, v228, v229
    v_cvt_pk_bf16_f32 v227, v230, v231
    buffer_store_dwordx4 v[172:175], v9, s[48:51], s45 offen offset:1024 sc0 sc1 nt
    ds_write_b128 v123, v[216:219] offset:0
    ds_read2_b64 v[196:199], v5 offset0:0 offset1:16
    ds_read2_b64 v[204:207], v6 offset0:0 offset1:16
    ds_read2_b64 v[212:215], v7 offset0:0 offset1:16
    ds_read2_b64 v[220:223], v8 offset0:0 offset1:16
    v_pk_fma_f32 v[232:233], v[232:233], v[110:111], v[118:119]
    v_pk_fma_f32 v[234:235], v[234:235], v[110:111], v[118:119]
    v_pk_fma_f32 v[236:237], v[236:237], v[110:111], v[118:119]
    v_pk_fma_f32 v[238:239], v[238:239], v[110:111], v[118:119]
    v_cvt_pk_bf16_f32 v232, v232, v233
    v_cvt_pk_bf16_f32 v233, v234, v235
    v_cvt_pk_bf16_f32 v234, v236, v237
    v_cvt_pk_bf16_f32 v235, v238, v239
    buffer_store_dwordx4 v[180:183], v9, s[48:51], s45 offen offset:2048 sc0 sc1 nt
    ds_write_b128 v120, v[224:227] offset:4096
    v_pk_fma_f32 v[240:241], v[240:241], v[110:111], v[118:119]
    v_pk_fma_f32 v[242:243], v[242:243], v[110:111], v[118:119]
    v_pk_fma_f32 v[244:245], v[244:245], v[110:111], v[118:119]
    v_pk_fma_f32 v[246:247], v[246:247], v[110:111], v[118:119]
    v_cvt_pk_bf16_f32 v240, v240, v241
    v_cvt_pk_bf16_f32 v241, v242, v243
    v_cvt_pk_bf16_f32 v242, v244, v245
    v_cvt_pk_bf16_f32 v243, v246, v247
    buffer_store_dwordx4 v[188:191], v9, s[48:51], s45 offen offset:3072 sc0 sc1 nt
    ds_write_b128 v121, v[232:235] offset:4096
    v_pk_fma_f32 v[248:249], v[248:249], v[110:111], v[118:119]
    v_pk_fma_f32 v[250:251], v[250:251], v[110:111], v[118:119]
    v_pk_fma_f32 v[252:253], v[252:253], v[110:111], v[118:119]
    v_pk_fma_f32 v[254:255], v[254:255], v[110:111], v[118:119]
    v_cvt_pk_bf16_f32 v248, v248, v249
    v_cvt_pk_bf16_f32 v249, v250, v251
    v_cvt_pk_bf16_f32 v250, v252, v253
    v_cvt_pk_bf16_f32 v251, v254, v255
    s_waitcnt lgkmcnt(2)
    buffer_store_dwordx4 v[196:199], v9, s[48:51], s46 offen sc0 sc1 nt
    ds_write_b128 v122, v[240:243] offset:4096
    buffer_store_dwordx4 v[204:207], v9, s[48:51], s46 offen offset:1024 sc0 sc1 nt
    ds_write_b128 v123, v[248:251] offset:4096
    ds_read2_b64 v[228:231], v124 offset0:0 offset1:16
    ds_read2_b64 v[236:239], v125 offset0:0 offset1:16
    ds_read2_b64 v[244:247], v126 offset0:0 offset1:16
    ds_read2_b64 v[252:255], v127 offset0:0 offset1:16
    s_waitcnt lgkmcnt(9)
    buffer_store_dwordx4 v[212:215], v9, s[48:51], s46 offen offset:2048 sc0 sc1 nt
    s_waitcnt lgkmcnt(8)
    buffer_store_dwordx4 v[220:223], v9, s[48:51], s46 offen offset:3072 sc0 sc1 nt
    s_waitcnt lgkmcnt(3)
    buffer_store_dwordx4 v[228:231], v9, s[48:51], s47 offen sc0 sc1 nt
    s_waitcnt lgkmcnt(2)
    buffer_store_dwordx4 v[236:239], v9, s[48:51], s47 offen offset:1024 sc0 sc1 nt
    s_waitcnt lgkmcnt(1)
    buffer_store_dwordx4 v[244:247], v9, s[48:51], s47 offen offset:2048 sc0 sc1 nt
    s_waitcnt lgkmcnt(0)
    buffer_store_dwordx4 v[252:255], v9, s[48:51], s47 offen offset:3072 sc0 sc1 nt
    s_branch L_fin
L_slow:
    s_waitcnt vmcnt(0) lgkmcnt(0)
    v_add_u32 v12, s12, v80
    v_add_u32 v13, s12, v81
    v_add_u32 v14, s12, v82
    v_add_u32 v15, s12, v83
    v_add_u32 v84, s12, v84
    v_subrev_u32 v84, s33, v84
    v_add_u32 v85, s12, v85
    v_subrev_u32 v85, s33, v85
    v_add_u32 v86, s12, v86
    v_subrev_u32 v86, s33, v86
    v_add_u32 v87, s12, v87
    v_subrev_u32 v87, s33, v87
    v_add_u32 v88, s12, v88
    v_subrev_u32 v88, s33, v88
    v_add_u32 v89, s12, v89
    v_subrev_u32 v89, s33, v89
    v_add_u32 v90, s12, v90
    v_subrev_u32 v90, s33, v90
    v_add_u32 v91, s12, v91
    v_subrev_u32 v91, s33, v91
    v_mov_b32 v48, 0
    v_mov_b32 v49, 0
    v_mov_b32 v50, 0
    v_mov_b32 v51, 0
    v_mov_b32 v52, 0
    v_mov_b32 v53, 0
    v_mov_b32 v54, 0
    v_mov_b32 v55, 0
    v_mov_b32 v56, 0
    v_mov_b32 v57, 0
    v_mov_b32 v58, 0
    v_mov_b32 v59, 0
    v_mov_b32 v60, 0
    v_mov_b32 v61, 0
    v_mov_b32 v62, 0
    v_mov_b32 v63, 0
    v_mov_b32 v64, v102
    v_mov_b32 v68, v102
    v_mov_b32 v72, v102
    v_mov_b32 v76, v102
    v_accvgpr_write_b32 a228, 0
    s_add_u32 s77, s4, 31
    s_lshr_b32 s77, s77, 5
    s_mov_b32 s78, 0
    v_mfma_f32_32x32x16_bf16 v[128:143], a[212:215], a[212:215], 0
    v_mfma_f32_32x32x16_bf16 v[144:159], a[212:215], a[212:215], 0
    v_mfma_f32_32x32x16_bf16 v[160:175], a[212:215], a[212:215], 0
    v_mfma_f32_32x32x16_bf16 v[176:191], a[212:215], a[212:215], 0
    v_mfma_f32_32x32x16_bf16 v[192:207], a[212:215], a[212:215], 0
    v_mfma_f32_32x32x16_bf16 v[208:223], a[212:215], a[212:215], 0
    v_mfma_f32_32x32x16_bf16 v[224:239], a[212:215], a[212:215], 0
    v_mfma_f32_32x32x16_bf16 v[240:255], a[212:215], a[212:215], 0
    v_mfma_f32_32x32x16_bf16 a[192:207], a[212:215], a[212:215], 0
L_slow_pass:
    s_mov_b32 s76, 0
L_slow_tile:
    s_lshl_b32 s34, s76, 3
    s_load_dwordx2 s[82:83], s[22:23], s34
    s_lshl_b32 s34, s76, 5
    s_sub_u32 s34, s4, s34
    v_lshlrev_b32 v10, 2, v3
    v_sub_u32 v10, s34, v10
    s_waitcnt lgkmcnt(0)
    s_min_u32 s82, s82, 0x83
    s_lshl_b32 s82, s82, 16
    s_add_u32 s79, s82, s15
    s_min_u32 s83, s83, 0x83
    s_lshl_b32 s83, s83, 16
    s_add_u32 s80, s83, s15
    s_add_u32 s40, s18, s79
    s_addc_u32 s41, s19, 0
    s_add_u32 m0, s12, 0
    s_nop 0
    global_load_lds_dwordx4 v92, s[40:41]
    global_load_lds_dwordx4 v93, s[40:41] offset:1024
    global_load_lds_dwordx4 v94, s[40:41] offset:2048
    global_load_lds_dwordx4 v95, s[40:41] offset:3072
    s_add_u32 s40, s18, s80
    s_addc_u32 s41, s19, 0
    s_add_u32 m0, s12, 16384
    s_nop 0
    global_load_lds_dwordx4 v92, s[40:41]
    global_load_lds_dwordx4 v93, s[40:41] offset:1024
    global_load_lds_dwordx4 v94, s[40:41] offset:2048
    global_load_lds_dwordx4 v95, s[40:41] offset:3072
    s_add_u32 s42, s20, s79
    s_addc_u32 s43, s21, 0
    s_add_u32 m0, s13, 0
    s_nop 0
    global_load_lds_dwordx4 v96, s[42:43]
    global_load_lds_dwordx4 v97, s[42:43] offset:1024
    global_load_lds_dwordx4 v98, s[42:43] offset:2048
    global_load_lds_dwordx4 v99, s[42:43] offset:3072
    s_add_u32 s42, s20, s80
    s_addc_u32 s43, s21, 0
    s_add_u32 m0, s13, 16384
    s_nop 0
    global_load_lds_dwordx4 v96, s[42:43]
    global_load_lds_dwordx4 v97, s[42:43] offset:1024
    global_load_lds_dwordx4 v98, s[42:43] offset:2048
    global_load_lds_dwordx4 v99, s[42:43] offset:3072
    v_cmp_lt_i32 s[60:61], 0, v10
    v_cmp_lt_i32 s[62:63], 1, v10
    v_cmp_lt_i32 s[64:65], 2, v10
    v_cmp_lt_i32 s[66:67], 3, v10
    v_cmp_lt_i32 s[68:69], 16, v10
    v_cmp_lt_i32 s[70:71], 17, v10
    v_cmp_lt_i32 s[72:73], 18, v10
    v_cmp_lt_i32 s[74:75], 19, v10
    s_waitcnt vmcnt(0)
    ds_read_b64_tr_b16 a[64:65], v84 offset:0
    ds_read_b64_tr_b16 a[66:67], v84 offset:16384
    ds_read_b64_tr_b16 a[72:73], v85 offset:0
    ds_read_b64_tr_b16 a[74:75], v85 offset:16384
    ds_read_b64_tr_b16 a[80:81], v86 offset:0
    ds_read_b64_tr_b16 a[82:83], v86 offset:16384
    ds_read_b64_tr_b16 a[88:89], v87 offset:0
    ds_read_b64_tr_b16 a[90:91], v87 offset:16384
    s_waitcnt lgkmcnt(0)
    ds_read_b64_tr_b16 a[96:97], v88 offset:0
    ds_read_b64_tr_b16 a[98:99], v88 offset:16384
    ds_read_b64_tr_b16 a[104:105], v89 offset:0
    ds_read_b64_tr_b16 a[106:107], v89 offset:16384
    ds_read_b64_tr_b16 a[112:113], v90 offset:0
    ds_read_b64_tr_b16 a[114:115], v90 offset:16384
    ds_read_b64_tr_b16 a[120:121], v91 offset:0
    ds_read_b64_tr_b16 a[122:123], v91 offset:16384
    s_waitcnt lgkmcnt(0)
    ds_read_b128 v[104:107], v12 offset:0
    ds_read_b128 v[108:111], v13 offset:0
    ds_read_b128 v[112:115], v14 offset:0
    ds_read_b128 v[116:119], v15 offset:0
    s_waitcnt lgkmcnt(0)
    v_mfma_f32_16x16x32_bf16 v[16:19], v[104:107], a[128:131], 0
    v_mfma_f32_16x16x32_bf16 v[16:19], v[108:111], a[132:135], v[16:19]
    v_mfma_f32_16x16x32_bf16 v[16:19], v[112:115], a[136:139], v[16:19]
    v_mfma_f32_16x16x32_bf16 v[16:19], v[116:119], a[140:143], v[16:19]
    v_mfma_f32_16x16x32_bf16 v[24:27], v[104:107], a[144:147], 0
    v_mfma_f32_16x16x32_bf16 v[24:27], v[108:111], a[148:151], v[24:27]
    v_mfma_f32_16x16x32_bf16 v[24:27], v[112:115], a[152:155], v[24:27]
    v_mfma_f32_16x16x32_bf16 v[24:27], v[116:119], a[156:159], v[24:27]
    v_mfma_f32_16x16x32_bf16 v[32:35], v[104:107], a[160:163], 0
    v_mfma_f32_16x16x32_bf16 v[32:35], v[108:111], a[164:167], v[32:35]
    v_mfma_f32_16x16x32_bf16 v[32:35], v[112:115], a[168:171], v[32:35]
    v_mfma_f32_16x16x32_bf16 v[32:35], v[116:119], a[172:175], v[32:35]
    v_mfma_f32_16x16x32_bf16 v[40:43], v[104:107], a[176:179], 0
    v_mfma_f32_16x16x32_bf16 v[40:43], v[108:111], a[180:183], v[40:43]
    v_mfma_f32_16x16x32_bf16 v[40:43], v[112:115], a[184:187], v[40:43]
    v_mfma_f32_16x16x32_bf16 v[40:43], v[116:119], a[188:191], v[40:43]
    ds_read_b128 v[104:107], v12 offset:16384
    ds_read_b128 v[108:111], v13 offset:16384
    ds_read_b128 v[112:115], v14 offset:16384
    ds_read_b128 v[116:119], v15 offset:16384
    s_waitcnt lgkmcnt(0)
    v_mfma_f32_16x16x32_bf16 v[20:23], v[104:107], a[128:131], 0
    v_mfma_f32_16x16x32_bf16 v[20:23], v[108:111], a[132:135], v[20:23]
    v_mfma_f32_16x16x32_bf16 v[20:23], v[112:115], a[136:139], v[20:23]
    v_mfma_f32_16x16x32_bf16 v[20:23], v[116:119], a[140:143], v[20:23]
    v_mfma_f32_16x16x32_bf16 v[28:31], v[104:107], a[144:147], 0
    v_mfma_f32_16x16x32_bf16 v[28:31], v[108:111], a[148:151], v[28:31]
    v_mfma_f32_16x16x32_bf16 v[28:31], v[112:115], a[152:155], v[28:31]
    v_mfma_f32_16x16x32_bf16 v[28:31], v[116:119], a[156:159], v[28:31]
    v_mfma_f32_16x16x32_bf16 v[36:39], v[104:107], a[160:163], 0
    v_mfma_f32_16x16x32_bf16 v[36:39], v[108:111], a[164:167], v[36:39]
    v_mfma_f32_16x16x32_bf16 v[36:39], v[112:115], a[168:171], v[36:39]
    v_mfma_f32_16x16x32_bf16 v[36:39], v[116:119], a[172:175], v[36:39]
    v_mfma_f32_16x16x32_bf16 v[44:47], v[104:107], a[176:179], 0
    v_mfma_f32_16x16x32_bf16 v[44:47], v[108:111], a[180:183], v[44:47]
    v_mfma_f32_16x16x32_bf16 v[44:47], v[112:115], a[184:187], v[44:47]
    v_mfma_f32_16x16x32_bf16 v[44:47], v[116:119], a[188:191], v[44:47]
    s_nop 7
    s_cmp_eq_u32 s35, 0
    s_cbranch_scc1 L_slow_nz
    v_mov_b32 v16, 0
    v_mov_b32 v17, 0
    v_mov_b32 v18, 0
    v_mov_b32 v19, 0
    v_mov_b32 v20, 0
    v_mov_b32 v21, 0
    v_mov_b32 v22, 0
    v_mov_b32 v23, 0
    v_mov_b32 v24, 0
    v_mov_b32 v25, 0
    v_mov_b32 v26, 0
    v_mov_b32 v27, 0
    v_mov_b32 v28, 0
    v_mov_b32 v29, 0
    v_mov_b32 v30, 0
    v_mov_b32 v31, 0
    v_mov_b32 v32, 0
    v_mov_b32 v33, 0
    v_mov_b32 v34, 0
    v_mov_b32 v35, 0
    v_mov_b32 v36, 0
    v_mov_b32 v37, 0
    v_mov_b32 v38, 0
    v_mov_b32 v39, 0
    v_mov_b32 v40, 0
    v_mov_b32 v41, 0
    v_mov_b32 v42, 0
    v_mov_b32 v43, 0
    v_mov_b32 v44, 0
    v_mov_b32 v45, 0
    v_mov_b32 v46, 0
    v_mov_b32 v47, 0
L_slow_nz:
    v_cndmask_b32 v16, v102, v16, s[60:61]
    v_cndmask_b32 v17, v102, v17, s[62:63]
    v_cndmask_b32 v18, v102, v18, s[64:65]
    v_cndmask_b32 v19, v102, v19, s[66:67]
    v_cndmask_b32 v20, v102, v20, s[68:69]
    v_cndmask_b32 v21, v102, v21, s[70:71]
    v_cndmask_b32 v22, v102, v22, s[72:73]
    v_cndmask_b32 v23, v102, v23, s[74:75]
    v_cndmask_b32 v24, v102, v24, s[60:61]
    v_cndmask_b32 v25, v102, v25, s[62:63]
    v_cndmask_b32 v26, v102, v26, s[64:65]
    v_cndmask_b32 v27, v102, v27, s[66:67]
    v_cndmask_b32 v28, v102, v28, s[68:69]
    v_cndmask_b32 v29, v102, v29, s[70:71]
    v_cndmask_b32 v30, v102, v30, s[72:73]
    v_cndmask_b32 v31, v102, v31, s[74:75]
    v_cndmask_b32 v32, v102, v32, s[60:61]
    v_cndmask_b32 v33, v102, v33, s[62:63]
    v_cndmask_b32 v34, v102, v34, s[64:65]
    v_cndmask_b32 v35, v102, v35, s[66:67]
    v_cndmask_b32 v36, v102, v36, s[68:69]
    v_cndmask_b32 v37, v102, v37, s[70:71]
    v_cndmask_b32 v38, v102, v38, s[72:73]
    v_cndmask_b32 v39, v102, v39, s[74:75]
    v_cndmask_b32 v40, v102, v40, s[60:61]
    v_cndmask_b32 v41, v102, v41, s[62:63]
    v_cndmask_b32 v42, v102, v42, s[64:65]
    v_cndmask_b32 v43, v102, v43, s[66:67]
    v_cndmask_b32 v44, v102, v44, s[68:69]
    v_cndmask_b32 v45, v102, v45, s[70:71]
    v_cndmask_b32 v46, v102, v46, s[72:73]
    v_cndmask_b32 v47, v102, v47, s[74:75]
    s_cmp_eq_u32 s78, 0
    s_cbranch_scc0 L_slow_p1
    v_max3_f32 v64, v64, v16, v17
    v_max3_f32 v64, v64, v18, v19
    v_max3_f32 v64, v64, v20, v21
    v_max3_f32 v64, v64, v22, v23
    v_max3_f32 v68, v68, v24, v25
    v_max3_f32 v68, v68, v26, v27
    v_max3_f32 v68, v68, v28, v29
    v_max3_f32 v68, v68, v30, v31
    v_max3_f32 v72, v72, v32, v33
    v_max3_f32 v72, v72, v34, v35
    v_max3_f32 v72, v72, v36, v37
    v_max3_f32 v72, v72, v38, v39
    v_max3_f32 v76, v76, v40, v41
    v_max3_f32 v76, v76, v42, v43
    v_max3_f32 v76, v76, v44, v45
    v_max3_f32 v76, v76, v46, v47
    s_branch L_slow_next
L_slow_p1:
    v_sub_f32 v16, v16, v64
    v_sub_f32 v17, v17, v64
    v_sub_f32 v18, v18, v64
    v_sub_f32 v19, v19, v64
    v_sub_f32 v20, v20, v64
    v_sub_f32 v21, v21, v64
    v_sub_f32 v22, v22, v64
    v_sub_f32 v23, v23, v64
    v_exp_f32 v16, v16
    v_exp_f32 v17, v17
    v_exp_f32 v18, v18
    v_exp_f32 v19, v19
    v_exp_f32 v20, v20
    v_exp_f32 v21, v21
    v_exp_f32 v22, v22
    v_exp_f32 v23, v23
    s_nop 0
    v_cvt_pk_bf16_f32 v48, v16, v17
    v_cvt_pk_bf16_f32 v49, v18, v19
    v_cvt_pk_bf16_f32 v50, v20, v21
    v_cvt_pk_bf16_f32 v51, v22, v23
    s_nop 1
    v_smfmac_f32_16x16x64_bf16 a[192:195], a[208:211], v[48:55], v101
    v_mfma_f32_16x16x32_bf16 v[128:131], a[64:67], v[48:51], v[128:131]
    v_mfma_f32_16x16x32_bf16 v[132:135], a[72:75], v[48:51], v[132:135]
    v_mfma_f32_16x16x32_bf16 v[136:139], a[80:83], v[48:51], v[136:139]
    v_mfma_f32_16x16x32_bf16 v[140:143], a[88:91], v[48:51], v[140:143]
    v_mfma_f32_16x16x32_bf16 v[144:147], a[96:99], v[48:51], v[144:147]
    v_mfma_f32_16x16x32_bf16 v[148:151], a[104:107], v[48:51], v[148:151]
    v_mfma_f32_16x16x32_bf16 v[152:155], a[112:115], v[48:51], v[152:155]
    v_mfma_f32_16x16x32_bf16 v[156:159], a[120:123], v[48:51], v[156:159]
    v_sub_f32 v24, v24, v68
    v_sub_f32 v25, v25, v68
    v_sub_f32 v26, v26, v68
    v_sub_f32 v27, v27, v68
    v_sub_f32 v28, v28, v68
    v_sub_f32 v29, v29, v68
    v_sub_f32 v30, v30, v68
    v_sub_f32 v31, v31, v68
    v_exp_f32 v24, v24
    v_exp_f32 v25, v25
    v_exp_f32 v26, v26
    v_exp_f32 v27, v27
    v_exp_f32 v28, v28
    v_exp_f32 v29, v29
    v_exp_f32 v30, v30
    v_exp_f32 v31, v31
    s_nop 0
    v_cvt_pk_bf16_f32 v56, v24, v25
    v_cvt_pk_bf16_f32 v57, v26, v27
    v_cvt_pk_bf16_f32 v58, v28, v29
    v_cvt_pk_bf16_f32 v59, v30, v31
    s_nop 1
    v_smfmac_f32_16x16x64_bf16 a[196:199], a[208:211], v[56:63], v101
    v_mfma_f32_16x16x32_bf16 v[160:163], a[64:67], v[56:59], v[160:163]
    v_mfma_f32_16x16x32_bf16 v[164:167], a[72:75], v[56:59], v[164:167]
    v_mfma_f32_16x16x32_bf16 v[168:171], a[80:83], v[56:59], v[168:171]
    v_mfma_f32_16x16x32_bf16 v[172:175], a[88:91], v[56:59], v[172:175]
    v_mfma_f32_16x16x32_bf16 v[176:179], a[96:99], v[56:59], v[176:179]
    v_mfma_f32_16x16x32_bf16 v[180:183], a[104:107], v[56:59], v[180:183]
    v_mfma_f32_16x16x32_bf16 v[184:187], a[112:115], v[56:59], v[184:187]
    v_mfma_f32_16x16x32_bf16 v[188:191], a[120:123], v[56:59], v[188:191]
    v_sub_f32 v32, v32, v72
    v_sub_f32 v33, v33, v72
    v_sub_f32 v34, v34, v72
    v_sub_f32 v35, v35, v72
    v_sub_f32 v36, v36, v72
    v_sub_f32 v37, v37, v72
    v_sub_f32 v38, v38, v72
    v_sub_f32 v39, v39, v72
    v_exp_f32 v32, v32
    v_exp_f32 v33, v33
    v_exp_f32 v34, v34
    v_exp_f32 v35, v35
    v_exp_f32 v36, v36
    v_exp_f32 v37, v37
    v_exp_f32 v38, v38
    v_exp_f32 v39, v39
    s_nop 0
    v_cvt_pk_bf16_f32 v48, v32, v33
    v_cvt_pk_bf16_f32 v49, v34, v35
    v_cvt_pk_bf16_f32 v50, v36, v37
    v_cvt_pk_bf16_f32 v51, v38, v39
    s_nop 1
    v_smfmac_f32_16x16x64_bf16 a[200:203], a[208:211], v[48:55], v101
    v_mfma_f32_16x16x32_bf16 v[192:195], a[64:67], v[48:51], v[192:195]
    v_mfma_f32_16x16x32_bf16 v[196:199], a[72:75], v[48:51], v[196:199]
    v_mfma_f32_16x16x32_bf16 v[200:203], a[80:83], v[48:51], v[200:203]
    v_mfma_f32_16x16x32_bf16 v[204:207], a[88:91], v[48:51], v[204:207]
    v_mfma_f32_16x16x32_bf16 v[208:211], a[96:99], v[48:51], v[208:211]
    v_mfma_f32_16x16x32_bf16 v[212:215], a[104:107], v[48:51], v[212:215]
    v_mfma_f32_16x16x32_bf16 v[216:219], a[112:115], v[48:51], v[216:219]
    v_mfma_f32_16x16x32_bf16 v[220:223], a[120:123], v[48:51], v[220:223]
    v_sub_f32 v40, v40, v76
    v_sub_f32 v41, v41, v76
    v_sub_f32 v42, v42, v76
    v_sub_f32 v43, v43, v76
    v_sub_f32 v44, v44, v76
    v_sub_f32 v45, v45, v76
    v_sub_f32 v46, v46, v76
    v_sub_f32 v47, v47, v76
    v_exp_f32 v40, v40
    v_exp_f32 v41, v41
    v_exp_f32 v42, v42
    v_exp_f32 v43, v43
    v_exp_f32 v44, v44
    v_exp_f32 v45, v45
    v_exp_f32 v46, v46
    v_exp_f32 v47, v47
    s_nop 0
    v_cvt_pk_bf16_f32 v56, v40, v41
    v_cvt_pk_bf16_f32 v57, v42, v43
    v_cvt_pk_bf16_f32 v58, v44, v45
    v_cvt_pk_bf16_f32 v59, v46, v47
    s_nop 1
    v_smfmac_f32_16x16x64_bf16 a[204:207], a[208:211], v[56:63], v101
    v_mfma_f32_16x16x32_bf16 v[224:227], a[64:67], v[56:59], v[224:227]
    v_mfma_f32_16x16x32_bf16 v[228:231], a[72:75], v[56:59], v[228:231]
    v_mfma_f32_16x16x32_bf16 v[232:235], a[80:83], v[56:59], v[232:235]
    v_mfma_f32_16x16x32_bf16 v[236:239], a[88:91], v[56:59], v[236:239]
    v_mfma_f32_16x16x32_bf16 v[240:243], a[96:99], v[56:59], v[240:243]
    v_mfma_f32_16x16x32_bf16 v[244:247], a[104:107], v[56:59], v[244:247]
    v_mfma_f32_16x16x32_bf16 v[248:251], a[112:115], v[56:59], v[248:251]
    v_mfma_f32_16x16x32_bf16 v[252:255], a[120:123], v[56:59], v[252:255]
L_slow_next:
    s_add_u32 s76, s76, 1
    s_cmp_lt_u32 s76, s77
    s_cbranch_scc1 L_slow_tile
    s_cmp_eq_u32 s78, 0
    s_cbranch_scc0 L_slow_done
    v_mov_b32 v65, v64
    v_mov_b32 v69, v68
    v_mov_b32 v73, v72
    v_mov_b32 v77, v76
    s_nop 1
    v_permlane32_swap_b32 v64, v65
    v_permlane32_swap_b32 v68, v69
    v_permlane32_swap_b32 v72, v73
    v_permlane32_swap_b32 v76, v77
    v_max_f32 v64, v64, v65
    v_max_f32 v68, v68, v69
    v_max_f32 v72, v72, v73
    v_max_f32 v76, v76, v77
    v_mov_b32 v65, v64
    v_mov_b32 v69, v68
    v_mov_b32 v73, v72
    v_mov_b32 v77, v76
    s_nop 1
    v_permlane16_swap_b32 v64, v65
    v_permlane16_swap_b32 v68, v69
    v_permlane16_swap_b32 v72, v73
    v_permlane16_swap_b32 v76, v77
    v_max_f32 v64, v64, v65
    v_max_f32 v68, v68, v69
    v_max_f32 v72, v72, v73
    v_max_f32 v76, v76, v77
    s_mov_b32 s78, 1
    s_branch L_slow_pass
L_slow_done:
    s_nop 7
    s_nop 7
    v_accvgpr_read_b32 v104, a192
    v_accvgpr_read_b32 v105, a193
    v_add_f32 v104, v104, v105
    v_accvgpr_read_b32 v106, a196
    v_accvgpr_read_b32 v107, a197
    v_add_f32 v106, v106, v107
    v_accvgpr_read_b32 v108, a200
    v_accvgpr_read_b32 v109, a201
    v_add_f32 v108, v108, v109
    v_accvgpr_read_b32 v110, a204
    v_accvgpr_read_b32 v111, a205
    v_add_f32 v110, v110, v111
    v_rcp_f32 v104, v104
    v_rcp_f32 v106, v106
    v_rcp_f32 v108, v108
    v_rcp_f32 v110, v110
    s_nop 0
    s_branch L_epi_ok
.section .rodata,"a"
.p2align 6
.amdhsa_kernel standalone__paged_block_table_kv_pagedattention__prompt_kernel
  .amdhsa_next_free_vgpr 512
  .amdhsa_next_free_sgpr 102
  .amdhsa_accum_offset 256
  .amdhsa_group_segment_fixed_size 0
  .amdhsa_kernarg_size 64
  .amdhsa_user_sgpr_count 2
  .amdhsa_user_sgpr_kernarg_segment_ptr 1
  .amdhsa_system_sgpr_workgroup_id_x 1
.end_amdhsa_kernel
```
